```python
import torch

def _softmax(x, axis=-1):
    return torch.softmax(x, dim=axis)
def _gelu(x):
    return torch.nn.functional.gelu(x, approximate="tanh")
def _silu(x):
    return torch.nn.functional.silu(x)
def _sigmoid(x):
    return torch.sigmoid(x)
def _layernorm(x, axis=-1, eps=1e-5):
    m = x.mean(dim=axis, keepdim=True)
    v = x.var(dim=axis, keepdim=True, unbiased=False)
    return (x - m) / torch.sqrt(v + eps)
def _scatter_add(tgt, idx, src, axis=0):
    return tgt.clone().index_add_(axis, idx, src)
def _segment_sum(src, seg, n):
    out = torch.zeros((n,) + src.shape[1:], dtype=src.dtype)
    return out.index_add_(0, seg, src)
def _pad(x, pw):
    flat = tuple(v for pair in reversed(pw) for v in pair)
    return torch.nn.functional.pad(x, flat)

kernel_name = 'concat_heads__gqa_block_cached__gqa_block_cached__near_ridge'

def setup_inputs():

    _w = (lambda a: (lambda t: t.to(torch.bfloat16) if t.is_floating_point() else t)(torch.as_tensor(a)))
    def _A_setup():
        B, Sq, D = 16, 128, 448
        Hq, Hkv, Sk, Dh = 16, 8, 512, 256
        assert Hq % Hkv == 0, (Hq, Hkv)
        return {
            "x": _w((lambda *s: torch.randn(*s, dtype=torch.bfloat16) * 0.8)(B, Sq, D)),
            "k_cache": _w((lambda *s: torch.randn(*s, dtype=torch.bfloat16) * 0.8)(B, Hkv, Sk, Dh)),
            "v_cache": _w((lambda *s: torch.randn(*s, dtype=torch.bfloat16) * 0.05)(B, Hkv, Sk, Dh)),
            "wq": _w((lambda *s: torch.randn(*s, dtype=torch.bfloat16) * 0.8)(D, Hq * Dh) * (D ** -0.5)),
            "wo": _w((lambda *s: torch.randn(*s, dtype=torch.bfloat16) * 0.05)(Hq * Dh, D) * ((Hq * Dh) ** -0.5)),
        }
    _A_in = _A_setup()

    def _B_setup():
        B, Sq, D = 16, 128, 448
        Hq, Hkv, Sk, Dh = 16, 8, 512, 256
        assert Hq % Hkv == 0, (Hq, Hkv)
        return {
            "x": _w((lambda *s: torch.randn(*s, dtype=torch.bfloat16) * 0.8)(B, Sq, D)),
            "k_cache": _w((lambda *s: torch.randn(*s, dtype=torch.bfloat16) * 0.8)(B, Hkv, Sk, Dh)),
            "v_cache": _w((lambda *s: torch.randn(*s, dtype=torch.bfloat16) * 0.05)(B, Hkv, Sk, Dh)),
            "wq": _w((lambda *s: torch.randn(*s, dtype=torch.bfloat16) * 0.8)(D, Hq * Dh) * (D ** -0.5)),
            "wo": _w((lambda *s: torch.randn(*s, dtype=torch.bfloat16) * 0.05)(Hq * Dh, D) * ((Hq * Dh) ** -0.5)),
        }
    _B_in = _B_setup()

    return {
        "A_x": _A_in["x"],
        "A_k_cache": _A_in["k_cache"],
        "A_v_cache": _A_in["v_cache"],
        "A_wq": _A_in["wq"],
        "A_wo": _A_in["wo"],
        "B_x": _B_in["x"],
        "B_k_cache": _B_in["k_cache"],
        "B_v_cache": _B_in["v_cache"],
        "B_wq": _B_in["wq"],
        "B_wo": _B_in["wo"],
    }

def reference(A_x, A_k_cache, A_v_cache, A_wq, A_wo, B_x, B_k_cache, B_v_cache, B_wq, B_wo):
    def _A_ref(x, k_cache, v_cache, wq, wo):
        B, Sq, D = x.shape
        Hq, Dh = 16, 256
        Hkv = k_cache.shape[1]
        rep = Hq // Hkv
        q = (lambda x, *d: x.permute(*d))((x @ wq).reshape(B, Sq, Hq, Dh), 0, 2, 1, 3)
        k = (lambda x, n, axis: torch.repeat_interleave(x, n, dim=axis))(k_cache, rep, axis=1)
        v = (lambda x, n, axis: torch.repeat_interleave(x, n, dim=axis))(v_cache, rep, axis=1)
        scores = torch.einsum("bhqd,bhkd->bhqk", q, k) * (Dh ** -0.5)
        p = _softmax(scores, axis=-1)
        o = torch.einsum("bhqk,bhkd->bhqd", p, v)
        return (lambda x, *d: x.permute(*d))(o, 0, 2, 1, 3).reshape(B, Sq, Hq * Dh) @ wo

    def _B_ref(x, k_cache, v_cache, wq, wo):
        B, Sq, D = x.shape
        Hq, Dh = 16, 256
        Hkv = k_cache.shape[1]
        rep = Hq // Hkv
        q = (lambda x, *d: x.permute(*d))((x @ wq).reshape(B, Sq, Hq, Dh), 0, 2, 1, 3)
        k = (lambda x, n, axis: torch.repeat_interleave(x, n, dim=axis))(k_cache, rep, axis=1)
        v = (lambda x, n, axis: torch.repeat_interleave(x, n, dim=axis))(v_cache, rep, axis=1)
        scores = torch.einsum("bhqd,bhkd->bhqk", q, k) * (Dh ** -0.5)
        p = _softmax(scores, axis=-1)
        o = torch.einsum("bhqk,bhkd->bhqd", p, v)
        return (lambda x, *d: x.permute(*d))(o, 0, 2, 1, 3).reshape(B, Sq, Hq * Dh) @ wo

    a = _A_ref(A_x, A_k_cache, A_v_cache, A_wq, A_wo)
    b = _B_ref(B_x, B_k_cache, B_v_cache, B_wq, B_wo)
    return torch.concatenate([a, b], axis=-1)
```

```asm
; @launch kernel=attn_kernel grid=(256,1,1) block=(512,1,1) lds=163840
; @launch kernel=reduce_kernel grid=(896,1,1) block=(256,1,1) lds=0
.amdgcn_target "amdgcn-amd-amdhsa--gfx950"
.text
.globl attn_kernel
.p2align 8
.type attn_kernel,@function
attn_kernel:
    s_cmp_ge_u32 s2, 256
    s_cbranch_scc1 L_attn_exit
    s_load_dwordx16 s[56:71], s[0:1], 0
    s_load_dwordx4 s[72:75], s[0:1], 64
    s_load_dwordx2 s[76:77], s[0:1], 96
    s_and_b32 s37, s2, 7
    s_lshr_b32 s38, s2, 3
    s_and_b32 s39, s38, 15
    s_mov_b32 s79, s39
    v_lshrrev_b32 v1, 6, v0
    v_and_b32 v255, 63, v0
    s_nop 0
    v_readfirstlane_b32 s32, v1
    s_nop 3
    s_lshr_b32 s33, s32, 2
    s_and_b32 s34, s32, 3
    s_bfe_u32 s90, s32, 65537
    s_lshl_b32 s90, s90, 3
    v_lshlrev_b32 v245, 4, v255
    v_bfe_u32 v1, v255, 4, 2
    v_sub_u32 v1, 4, v1
    v_and_b32 v1, 3, v1
    v_and_b32 v2, 3, v255
    v_xor_b32 v1, v1, v2
    v_lshlrev_b32 v1, 4, v1
    v_lshrrev_b32 v2, 2, v255
    v_mul_u32_u24 v2, 896, v2
    v_add_u32 v247, v1, v2
    s_mul_i32 s48, s32, 4352
    s_add_u32 s48, s48, s90
    s_lshl_b32 s45, s32, 15
    s_mov_b32 s36, 0
    s_mov_b32 s35, 0
    s_mul_i32 s47, s32, 14336
    s_lshl_b32 s52, s32, 10
    s_add_u32 s52, s52, 139264
    s_mov_b32 s53, 0
    s_mov_b32 s54, 0
    s_waitcnt lgkmcnt(0)
    s_cmp_ge_u32 s38, 16
    s_cselect_b32 s56, s66, s56
    s_cselect_b32 s57, s67, s57
    s_cselect_b32 s58, s68, s58
    s_cselect_b32 s59, s69, s59
    s_cselect_b32 s60, s70, s60
    s_cselect_b32 s61, s71, s61
    s_cselect_b32 s62, s72, s62
    s_cselect_b32 s63, s73, s63
    s_cselect_b32 s64, s74, s64
    s_cselect_b32 s65, s75, s65
    s_lshl_b32 s40, s37, 10
    s_add_u32 s62, s62, s40
    s_addc_u32 s63, s63, 0
    s_mov_b32 s20, s62
    s_and_b32 s21, s63, 0xffff
    s_mov_b32 s22, 3670016
    s_mov_b32 s23, 0x00020000
    s_sub_u32 s22, s22, s40
    s_mul_i32 s40, s39, 114688
    s_add_u32 s56, s56, s40
    s_addc_u32 s57, s57, 0
    s_mov_b32 s8, s56
    s_and_b32 s9, s57, 0xffff
    s_mov_b32 s10, 114688
    s_mov_b32 s11, 0x00020000
    s_lshl_b32 s40, s39, 3
    s_add_u32 s40, s40, s37
    s_lshl_b32 s40, s40, 18
    s_add_u32 s58, s58, s40
    s_addc_u32 s59, s59, 0
    s_mov_b32 s12, s58
    s_and_b32 s13, s59, 0xffff
    s_mov_b32 s14, 262144
    s_mov_b32 s15, 0x00020000
    s_add_u32 s60, s60, s40
    s_addc_u32 s61, s61, 0
    s_mov_b32 s16, s60
    s_and_b32 s17, s61, 0xffff
    s_mov_b32 s18, 262144
    s_mov_b32 s19, 0x00020000
    s_mul_i32 s40, s37, 458752
    s_add_u32 s64, s64, s40
    s_addc_u32 s65, s65, 0
    s_mov_b32 s24, s64
    s_and_b32 s25, s65, 0xffff
    s_mov_b32 s26, 458752
    s_mov_b32 s27, 0x00020000
    s_mul_i32 s40, s2, 114688
    s_add_u32 s76, s76, s40
    s_addc_u32 s77, s77, 0
    s_mov_b32 s28, s76
    s_and_b32 s29, s77, 0xffff
    s_mov_b32 s30, 114688
    s_mov_b32 s31, 0x00020000
    s_add_u32 s55, s36, s48
    s_add_u32 s36, s36, 34816
    s_cmp_ge_u32 s36, 139264
    s_cselect_b32 s40, 139264, 0
    s_sub_u32 s36, s36, s40
    s_add_u32 s38, s45, 0
    s_add_u32 m0, s55, 0
    s_nop 0
    buffer_load_dwordx4 v245, s[20:23], s38 offen lds
    s_add_u32 s38, s45, 8192
    s_add_u32 m0, s55, 1088
    s_nop 0
    buffer_load_dwordx4 v245, s[20:23], s38 offen lds
    s_add_u32 s38, s45, 16384
    s_add_u32 m0, s55, 2176
    s_nop 0
    buffer_load_dwordx4 v245, s[20:23], s38 offen lds
    s_add_u32 s38, s45, 24576
    s_add_u32 m0, s55, 3264
    s_nop 0
    buffer_load_dwordx4 v245, s[20:23], s38 offen lds
    s_add_u32 s45, s45, 262144
    s_add_u32 s37, s52, s54
    s_add_u32 m0, s37, 0
    s_nop 0
    buffer_load_dwordx4 v247, s[8:11], s47 offen lds
    s_add_u32 s47, s47, 64
    s_add_u32 s54, s54, 8192
    s_cmp_ge_u32 s54, 24576
    s_cselect_b32 s54, 0, s54
    s_add_u32 s55, s36, s48
    s_add_u32 s36, s36, 34816
    s_cmp_ge_u32 s36, 139264
    s_cselect_b32 s40, 139264, 0
    s_sub_u32 s36, s36, s40
    s_add_u32 s38, s45, 0
    s_add_u32 m0, s55, 0
    s_nop 0
    buffer_load_dwordx4 v245, s[20:23], s38 offen lds
    s_add_u32 s38, s45, 8192
    s_add_u32 m0, s55, 1088
    s_nop 0
    buffer_load_dwordx4 v245, s[20:23], s38 offen lds
    s_add_u32 s38, s45, 16384
    s_add_u32 m0, s55, 2176
    s_nop 0
    buffer_load_dwordx4 v245, s[20:23], s38 offen lds
    s_add_u32 s38, s45, 24576
    s_add_u32 m0, s55, 3264
    s_nop 0
    buffer_load_dwordx4 v245, s[20:23], s38 offen lds
    s_add_u32 s45, s45, 262144
    s_add_u32 s37, s52, s54
    s_add_u32 m0, s37, 0
    s_nop 0
    buffer_load_dwordx4 v247, s[8:11], s47 offen lds
    s_add_u32 s47, s47, 64
    s_add_u32 s54, s54, 8192
    s_cmp_ge_u32 s54, 24576
    s_cselect_b32 s54, 0, s54
    s_add_u32 s55, s36, s48
    s_add_u32 s36, s36, 34816
    s_cmp_ge_u32 s36, 139264
    s_cselect_b32 s40, 139264, 0
    s_sub_u32 s36, s36, s40
    s_add_u32 s38, s45, 0
    s_add_u32 m0, s55, 0
    s_nop 0
    buffer_load_dwordx4 v245, s[20:23], s38 offen lds
    s_add_u32 s38, s45, 8192
    s_add_u32 m0, s55, 1088
    s_nop 0
    buffer_load_dwordx4 v245, s[20:23], s38 offen lds
    s_add_u32 s38, s45, 16384
    s_add_u32 m0, s55, 2176
    s_nop 0
    buffer_load_dwordx4 v245, s[20:23], s38 offen lds
    s_add_u32 s38, s45, 24576
    s_add_u32 m0, s55, 3264
    s_nop 0
    buffer_load_dwordx4 v245, s[20:23], s38 offen lds
    s_add_u32 s45, s45, 262144
    v_lshrrev_b32 v1, 4, v255
    v_lshlrev_b32 v1, 13, v1
    v_and_b32 v2, 15, v255
    v_lshl_add_u32 v1, v2, 6, v1
    s_mul_i32 s37, s79, 28
    s_lshl_b32 s38, s32, 2
    s_add_u32 s37, s37, s38
    s_lshl_b32 s37, s37, 13
    buffer_load_dword v254, v1, s[20:23], s37 offen
    s_mov_b32 s42, 0x3db8aa3b
    s_mov_b32 s43, 0xbdb8aa3b
    s_mov_b32 s44, 0x41000000
    v_lshrrev_b32 v1, 4, v255
    v_bfe_u32 v2, v255, 2, 2
    v_lshl_add_u32 v2, v1, 3, v2
    v_mul_u32_u24 v2, 1088, v2
    v_and_b32 v1, 1, v1
    v_lshl_add_u32 v2, v1, 3, v2
    v_and_b32 v1, 3, v255
    v_lshl_add_u32 v2, v1, 4, v2
    s_lshl_b32 s40, s33, 9
    v_add_u32 v240, s40, v2
    v_bfe_u32 v1, v255, 2, 2
    v_sub_u32 v1, 4, v1
    v_and_b32 v1, 3, v1
    v_lshrrev_b32 v2, 4, v255
    v_xor_b32 v1, v1, v2
    v_lshlrev_b32 v1, 4, v1
    v_and_b32 v2, 15, v255
    v_lshl_add_u32 v1, v2, 6, v1
    s_lshl_b32 s40, s34, 11
    s_add_u32 s40, s40, 139264
    v_add_u32 v241, s40, v1
    v_lshrrev_b32 v2, 5, v255
    v_and_b32 v1, 31, v255
    v_xor_b32 v1, v1, v2
    v_lshlrev_b32 v1, 4, v1
    v_lshl_add_u32 v246, v2, 9, v1
    v_add_u32 v242, s35, v240
    s_waitcnt vmcnt(9)
    s_barrier
    v_add_u32 v243, s53, v241
    ds_read_b128 v[192:195], v243 offset:0
    ds_read_b128 v[196:199], v243 offset:1024
    s_add_u32 s53, s53, 8192
    s_cmp_ge_u32 s53, 24576
    s_cselect_b32 s53, 0, s53
    s_waitcnt lgkmcnt(0)
    s_and_b32 s37, s32, 1
    s_cmp_eq_u32 s37, 1
    s_cselect_b32 s60, s16, s12
    s_cselect_b32 s61, s17, s13
    s_cselect_b32 s62, s18, s14
    s_cselect_b32 s63, s19, s15
    s_lshr_b32 s91, s2, 4
    s_xor_b32 s91, s91, s2
    s_add_u32 s91, s91, 2
    s_add_u32 s91, s91, s33
    s_and_b32 s91, s91, 15
    s_lshl_b32 s91, s91, 14
    s_lshl_b32 s37, s90, 10
    s_add_u32 s91, s91, s37
    v_lshlrev_b32 v129, 7, v255
    ds_read_b64_tr_b16 v[224:225], v242 offset:0
    ds_read_b64_tr_b16 v[226:227], v242 offset:4352
    ds_read_b64_tr_b16 v[228:229], v242 offset:8
    ds_read_b64_tr_b16 v[230:231], v242 offset:4360
    ds_read_b64_tr_b16 v[232:233], v242 offset:64
    ds_read_b64_tr_b16 v[234:235], v242 offset:4416
    s_waitcnt lgkmcnt(4)
    v_mfma_f32_16x16x32_bf16 v[0:3], v[224:227], v[192:195], 0
    ds_read_b64_tr_b16 v[236:237], v242 offset:72
    ds_read_b64_tr_b16 v[238:239], v242 offset:4424
    v_mfma_f32_16x16x32_bf16 v[4:7], v[224:227], v[196:199], 0
    s_waitcnt lgkmcnt(4)
    v_mfma_f32_16x16x32_bf16 v[8:11], v[228:231], v[192:195], 0
    ds_read_b64_tr_b16 v[224:225], v242 offset:128
    ds_read_b64_tr_b16 v[226:227], v242 offset:4480
    v_mfma_f32_16x16x32_bf16 v[12:15], v[228:231], v[196:199], 0
    s_waitcnt lgkmcnt(4)
    v_mfma_f32_16x16x32_bf16 v[16:19], v[232:235], v[192:195], 0
    ds_read_b64_tr_b16 v[228:229], v242 offset:136
    ds_read_b64_tr_b16 v[230:231], v242 offset:4488
    v_mfma_f32_16x16x32_bf16 v[20:23], v[232:235], v[196:199], 0
    s_waitcnt lgkmcnt(4)
    v_mfma_f32_16x16x32_bf16 v[24:27], v[236:239], v[192:195], 0
    ds_read_b64_tr_b16 v[232:233], v242 offset:192
    ds_read_b64_tr_b16 v[234:235], v242 offset:4544
    v_mfma_f32_16x16x32_bf16 v[28:31], v[236:239], v[196:199], 0
    s_waitcnt lgkmcnt(4)
    v_mfma_f32_16x16x32_bf16 v[32:35], v[224:227], v[192:195], 0
    ds_read_b64_tr_b16 v[236:237], v242 offset:200
    ds_read_b64_tr_b16 v[238:239], v242 offset:4552
    v_mfma_f32_16x16x32_bf16 v[36:39], v[224:227], v[196:199], 0
    s_waitcnt lgkmcnt(4)
    v_mfma_f32_16x16x32_bf16 v[40:43], v[228:231], v[192:195], 0
    ds_read_b64_tr_b16 v[224:225], v242 offset:256
    ds_read_b64_tr_b16 v[226:227], v242 offset:4608
    v_mfma_f32_16x16x32_bf16 v[44:47], v[228:231], v[196:199], 0
    s_waitcnt lgkmcnt(4)
    v_mfma_f32_16x16x32_bf16 v[48:51], v[232:235], v[192:195], 0
    ds_read_b64_tr_b16 v[228:229], v242 offset:264
    ds_read_b64_tr_b16 v[230:231], v242 offset:4616
    v_mfma_f32_16x16x32_bf16 v[52:55], v[232:235], v[196:199], 0
    s_waitcnt lgkmcnt(4)
    v_mfma_f32_16x16x32_bf16 v[56:59], v[236:239], v[192:195], 0
    ds_read_b64_tr_b16 v[232:233], v242 offset:320
    ds_read_b64_tr_b16 v[234:235], v242 offset:4672
    v_mfma_f32_16x16x32_bf16 v[60:63], v[236:239], v[196:199], 0
    s_waitcnt vmcnt(4)
    s_barrier
    v_add_u32 v243, s53, v241
    ds_read_b128 v[208:211], v243 offset:0
    ds_read_b128 v[212:215], v243 offset:1024
    s_add_u32 s53, s53, 8192
    s_cmp_ge_u32 s53, 24576
    s_cselect_b32 s53, 0, s53
    s_add_u32 s55, s36, s48
    s_add_u32 s36, s36, 34816
    s_cmp_ge_u32 s36, 139264
    s_cselect_b32 s40, 139264, 0
    s_sub_u32 s36, s36, s40
    s_waitcnt lgkmcnt(6)
    v_mfma_f32_16x16x32_bf16 v[64:67], v[224:227], v[192:195], 0
    ds_read_b64_tr_b16 v[236:237], v242 offset:328
    ds_read_b64_tr_b16 v[238:239], v242 offset:4680
    v_mfma_f32_16x16x32_bf16 v[68:71], v[224:227], v[196:199], 0
    s_add_u32 s37, s52, s54
    s_add_u32 m0, s37, 0
    s_nop 0
    buffer_load_dwordx4 v247, s[8:11], s47 offen lds
    s_add_u32 s47, s47, 64
    s_add_u32 s54, s54, 8192
    s_cmp_ge_u32 s54, 24576
    s_cselect_b32 s54, 0, s54
    s_waitcnt lgkmcnt(6)
    v_mfma_f32_16x16x32_bf16 v[72:75], v[228:231], v[192:195], 0
    ds_read_b64_tr_b16 v[224:225], v242 offset:384
    ds_read_b64_tr_b16 v[226:227], v242 offset:4736
    v_mfma_f32_16x16x32_bf16 v[76:79], v[228:231], v[196:199], 0
    s_add_u32 s38, s45, 0
    s_add_u32 m0, s55, 0
    s_nop 0
    buffer_load_dwordx4 v245, s[20:23], s38 offen lds
    s_waitcnt lgkmcnt(6)
    v_mfma_f32_16x16x32_bf16 v[80:83], v[232:235], v[192:195], 0
    ds_read_b64_tr_b16 v[228:229], v242 offset:392
    ds_read_b64_tr_b16 v[230:231], v242 offset:4744
    v_mfma_f32_16x16x32_bf16 v[84:87], v[232:235], v[196:199], 0
    s_add_u32 s38, s45, 8192
    s_add_u32 m0, s55, 1088
    s_nop 0
    buffer_load_dwordx4 v245, s[20:23], s38 offen lds
    s_waitcnt lgkmcnt(4)
    v_mfma_f32_16x16x32_bf16 v[88:91], v[236:239], v[192:195], 0
    ds_read_b64_tr_b16 v[232:233], v242 offset:448
    ds_read_b64_tr_b16 v[234:235], v242 offset:4800
    v_mfma_f32_16x16x32_bf16 v[92:95], v[236:239], v[196:199], 0
    s_add_u32 s38, s45, 16384
    s_add_u32 m0, s55, 2176
    s_nop 0
    buffer_load_dwordx4 v245, s[20:23], s38 offen lds
    s_waitcnt lgkmcnt(4)
    v_mfma_f32_16x16x32_bf16 v[96:99], v[224:227], v[192:195], 0
    ds_read_b64_tr_b16 v[236:237], v242 offset:456
    ds_read_b64_tr_b16 v[238:239], v242 offset:4808
    v_mfma_f32_16x16x32_bf16 v[100:103], v[224:227], v[196:199], 0
    s_add_u32 s38, s45, 24576
    s_add_u32 m0, s55, 3264
    s_nop 0
    buffer_load_dwordx4 v245, s[20:23], s38 offen lds
    s_add_u32 s45, s45, 262144
    s_waitcnt lgkmcnt(4)
    v_mfma_f32_16x16x32_bf16 v[104:107], v[228:231], v[192:195], 0
    s_add_u32 s35, s35, 34816
    s_cmp_ge_u32 s35, 139264
    s_cselect_b32 s40, 139264, 0
    s_sub_u32 s35, s35, s40
    v_add_u32 v242, s35, v240
    ds_read_b64_tr_b16 v[224:225], v242 offset:0
    ds_read_b64_tr_b16 v[226:227], v242 offset:4352
    v_mfma_f32_16x16x32_bf16 v[108:111], v[228:231], v[196:199], 0
    buffer_load_dword v128, v129, s[60:63], s91 offen
    s_add_u32 s91, s91, 32768
    s_and_b32 s91, s91, 0x3ffff
    s_waitcnt lgkmcnt(4)
    v_mfma_f32_16x16x32_bf16 v[112:115], v[232:235], v[192:195], 0
    ds_read_b64_tr_b16 v[228:229], v242 offset:8
    ds_read_b64_tr_b16 v[230:231], v242 offset:4360
    v_mfma_f32_16x16x32_bf16 v[116:119], v[232:235], v[196:199], 0
    s_waitcnt lgkmcnt(4)
    v_mfma_f32_16x16x32_bf16 v[120:123], v[236:239], v[192:195], 0
    ds_read_b64_tr_b16 v[232:233], v242 offset:64
    ds_read_b64_tr_b16 v[234:235], v242 offset:4416
    v_mfma_f32_16x16x32_bf16 v[124:127], v[236:239], v[196:199], 0
    s_mov_b32 s41, 5
L_p1:
    s_waitcnt lgkmcnt(4)
    v_mfma_f32_16x16x32_bf16 v[0:3], v[224:227], v[208:211], v[0:3]
    ds_read_b64_tr_b16 v[236:237], v242 offset:72
    ds_read_b64_tr_b16 v[238:239], v242 offset:4424
    v_mfma_f32_16x16x32_bf16 v[4:7], v[224:227], v[212:215], v[4:7]
    s_waitcnt lgkmcnt(4)
    v_mfma_f32_16x16x32_bf16 v[8:11], v[228:231], v[208:211], v[8:11]
    ds_read_b64_tr_b16 v[224:225], v242 offset:128
    ds_read_b64_tr_b16 v[226:227], v242 offset:4480
    v_mfma_f32_16x16x32_bf16 v[12:15], v[228:231], v[212:215], v[12:15]
    s_waitcnt lgkmcnt(4)
    v_mfma_f32_16x16x32_bf16 v[16:19], v[232:235], v[208:211], v[16:19]
    ds_read_b64_tr_b16 v[228:229], v242 offset:136
    ds_read_b64_tr_b16 v[230:231], v242 offset:4488
    v_mfma_f32_16x16x32_bf16 v[20:23], v[232:235], v[212:215], v[20:23]
    s_waitcnt lgkmcnt(4)
    v_mfma_f32_16x16x32_bf16 v[24:27], v[236:239], v[208:211], v[24:27]
    ds_read_b64_tr_b16 v[232:233], v242 offset:192
    ds_read_b64_tr_b16 v[234:235], v242 offset:4544
    v_mfma_f32_16x16x32_bf16 v[28:31], v[236:239], v[212:215], v[28:31]
    s_waitcnt lgkmcnt(4)
    v_mfma_f32_16x16x32_bf16 v[32:35], v[224:227], v[208:211], v[32:35]
    ds_read_b64_tr_b16 v[236:237], v242 offset:200
    ds_read_b64_tr_b16 v[238:239], v242 offset:4552
    v_mfma_f32_16x16x32_bf16 v[36:39], v[224:227], v[212:215], v[36:39]
    s_waitcnt lgkmcnt(4)
    v_mfma_f32_16x16x32_bf16 v[40:43], v[228:231], v[208:211], v[40:43]
    ds_read_b64_tr_b16 v[224:225], v242 offset:256
    ds_read_b64_tr_b16 v[226:227], v242 offset:4608
    v_mfma_f32_16x16x32_bf16 v[44:47], v[228:231], v[212:215], v[44:47]
    s_waitcnt lgkmcnt(4)
    v_mfma_f32_16x16x32_bf16 v[48:51], v[232:235], v[208:211], v[48:51]
    ds_read_b64_tr_b16 v[228:229], v242 offset:264
    ds_read_b64_tr_b16 v[230:231], v242 offset:4616
    v_mfma_f32_16x16x32_bf16 v[52:55], v[232:235], v[212:215], v[52:55]
    s_waitcnt lgkmcnt(4)
    v_mfma_f32_16x16x32_bf16 v[56:59], v[236:239], v[208:211], v[56:59]
    ds_read_b64_tr_b16 v[232:233], v242 offset:320
    ds_read_b64_tr_b16 v[234:235], v242 offset:4672
    v_mfma_f32_16x16x32_bf16 v[60:63], v[236:239], v[212:215], v[60:63]
    s_waitcnt vmcnt(4)
    s_barrier
    v_add_u32 v243, s53, v241
    ds_read_b128 v[192:195], v243 offset:0
    ds_read_b128 v[196:199], v243 offset:1024
    s_add_u32 s53, s53, 8192
    s_cmp_ge_u32 s53, 24576
    s_cselect_b32 s53, 0, s53
    s_add_u32 s55, s36, s48
    s_add_u32 s36, s36, 34816
    s_cmp_ge_u32 s36, 139264
    s_cselect_b32 s40, 139264, 0
    s_sub_u32 s36, s36, s40
    s_waitcnt lgkmcnt(6)
    v_mfma_f32_16x16x32_bf16 v[64:67], v[224:227], v[208:211], v[64:67]
    ds_read_b64_tr_b16 v[236:237], v242 offset:328
    ds_read_b64_tr_b16 v[238:239], v242 offset:4680
    v_mfma_f32_16x16x32_bf16 v[68:71], v[224:227], v[212:215], v[68:71]
    s_waitcnt lgkmcnt(6)
    v_mfma_f32_16x16x32_bf16 v[72:75], v[228:231], v[208:211], v[72:75]
    ds_read_b64_tr_b16 v[224:225], v242 offset:384
    ds_read_b64_tr_b16 v[226:227], v242 offset:4736
    s_add_u32 s37, s52, s54
    s_add_u32 m0, s37, 0
    s_nop 0
    buffer_load_dwordx4 v247, s[8:11], s47 offen lds
    s_add_u32 s47, s47, 64
    s_add_u32 s54, s54, 8192
    s_cmp_ge_u32 s54, 24576
    s_cselect_b32 s54, 0, s54
    v_mfma_f32_16x16x32_bf16 v[76:79], v[228:231], v[212:215], v[76:79]
    s_waitcnt lgkmcnt(6)
    v_mfma_f32_16x16x32_bf16 v[80:83], v[232:235], v[208:211], v[80:83]
    ds_read_b64_tr_b16 v[228:229], v242 offset:392
    ds_read_b64_tr_b16 v[230:231], v242 offset:4744
    v_mfma_f32_16x16x32_bf16 v[84:87], v[232:235], v[212:215], v[84:87]
    s_add_u32 s38, s45, 0
    s_add_u32 m0, s55, 0
    s_nop 0
    buffer_load_dwordx4 v245, s[20:23], s38 offen lds
    s_waitcnt lgkmcnt(4)
    v_mfma_f32_16x16x32_bf16 v[88:91], v[236:239], v[208:211], v[88:91]
    ds_read_b64_tr_b16 v[232:233], v242 offset:448
    ds_read_b64_tr_b16 v[234:235], v242 offset:4800
    v_mfma_f32_16x16x32_bf16 v[92:95], v[236:239], v[212:215], v[92:95]
    s_waitcnt lgkmcnt(4)
    v_mfma_f32_16x16x32_bf16 v[96:99], v[224:227], v[208:211], v[96:99]
    ds_read_b64_tr_b16 v[236:237], v242 offset:456
    ds_read_b64_tr_b16 v[238:239], v242 offset:4808
    s_add_u32 s38, s45, 8192
    s_add_u32 m0, s55, 1088
    s_nop 0
    buffer_load_dwordx4 v245, s[20:23], s38 offen lds
    v_mfma_f32_16x16x32_bf16 v[100:103], v[224:227], v[212:215], v[100:103]
    s_waitcnt lgkmcnt(4)
    v_mfma_f32_16x16x32_bf16 v[104:107], v[228:231], v[208:211], v[104:107]
    s_add_u32 s35, s35, 34816
    s_cmp_ge_u32 s35, 139264
    s_cselect_b32 s40, 139264, 0
    s_sub_u32 s35, s35, s40
    v_add_u32 v242, s35, v240
    ds_read_b64_tr_b16 v[224:225], v242 offset:0
    ds_read_b64_tr_b16 v[226:227], v242 offset:4352
    v_mfma_f32_16x16x32_bf16 v[108:111], v[228:231], v[212:215], v[108:111]
    s_add_u32 s38, s45, 16384
    s_add_u32 m0, s55, 2176
    s_nop 0
    buffer_load_dwordx4 v245, s[20:23], s38 offen lds
    s_waitcnt lgkmcnt(4)
    v_mfma_f32_16x16x32_bf16 v[112:115], v[232:235], v[208:211], v[112:115]
    ds_read_b64_tr_b16 v[228:229], v242 offset:8
    ds_read_b64_tr_b16 v[230:231], v242 offset:4360
    v_mfma_f32_16x16x32_bf16 v[116:119], v[232:235], v[212:215], v[116:119]
    s_waitcnt lgkmcnt(4)
    v_mfma_f32_16x16x32_bf16 v[120:123], v[236:239], v[208:211], v[120:123]
    ds_read_b64_tr_b16 v[232:233], v242 offset:64
    ds_read_b64_tr_b16 v[234:235], v242 offset:4416
    s_add_u32 s38, s45, 24576
    s_add_u32 m0, s55, 3264
    s_nop 0
    buffer_load_dwordx4 v245, s[20:23], s38 offen lds
    s_add_u32 s45, s45, 262144
    v_mfma_f32_16x16x32_bf16 v[124:127], v[236:239], v[212:215], v[124:127]
    s_waitcnt lgkmcnt(4)
    v_mfma_f32_16x16x32_bf16 v[0:3], v[224:227], v[192:195], v[0:3]
    ds_read_b64_tr_b16 v[236:237], v242 offset:72
    ds_read_b64_tr_b16 v[238:239], v242 offset:4424
    v_mfma_f32_16x16x32_bf16 v[4:7], v[224:227], v[196:199], v[4:7]
    s_waitcnt lgkmcnt(4)
    v_mfma_f32_16x16x32_bf16 v[8:11], v[228:231], v[192:195], v[8:11]
    ds_read_b64_tr_b16 v[224:225], v242 offset:128
    ds_read_b64_tr_b16 v[226:227], v242 offset:4480
    v_mfma_f32_16x16x32_bf16 v[12:15], v[228:231], v[196:199], v[12:15]
    s_waitcnt lgkmcnt(4)
    v_mfma_f32_16x16x32_bf16 v[16:19], v[232:235], v[192:195], v[16:19]
    ds_read_b64_tr_b16 v[228:229], v242 offset:136
    ds_read_b64_tr_b16 v[230:231], v242 offset:4488
    v_mfma_f32_16x16x32_bf16 v[20:23], v[232:235], v[196:199], v[20:23]
    s_waitcnt lgkmcnt(4)
    v_mfma_f32_16x16x32_bf16 v[24:27], v[236:239], v[192:195], v[24:27]
    ds_read_b64_tr_b16 v[232:233], v242 offset:192
    ds_read_b64_tr_b16 v[234:235], v242 offset:4544
    v_mfma_f32_16x16x32_bf16 v[28:31], v[236:239], v[196:199], v[28:31]
    s_waitcnt lgkmcnt(4)
    v_mfma_f32_16x16x32_bf16 v[32:35], v[224:227], v[192:195], v[32:35]
    ds_read_b64_tr_b16 v[236:237], v242 offset:200
    ds_read_b64_tr_b16 v[238:239], v242 offset:4552
    v_mfma_f32_16x16x32_bf16 v[36:39], v[224:227], v[196:199], v[36:39]
    s_waitcnt lgkmcnt(4)
    v_mfma_f32_16x16x32_bf16 v[40:43], v[228:231], v[192:195], v[40:43]
    ds_read_b64_tr_b16 v[224:225], v242 offset:256
    ds_read_b64_tr_b16 v[226:227], v242 offset:4608
    v_mfma_f32_16x16x32_bf16 v[44:47], v[228:231], v[196:199], v[44:47]
    s_waitcnt lgkmcnt(4)
    v_mfma_f32_16x16x32_bf16 v[48:51], v[232:235], v[192:195], v[48:51]
    ds_read_b64_tr_b16 v[228:229], v242 offset:264
    ds_read_b64_tr_b16 v[230:231], v242 offset:4616
    v_mfma_f32_16x16x32_bf16 v[52:55], v[232:235], v[196:199], v[52:55]
    s_waitcnt lgkmcnt(4)
    v_mfma_f32_16x16x32_bf16 v[56:59], v[236:239], v[192:195], v[56:59]
    ds_read_b64_tr_b16 v[232:233], v242 offset:320
    ds_read_b64_tr_b16 v[234:235], v242 offset:4672
    v_mfma_f32_16x16x32_bf16 v[60:63], v[236:239], v[196:199], v[60:63]
    s_waitcnt vmcnt(4)
    s_barrier
    v_add_u32 v243, s53, v241
    ds_read_b128 v[208:211], v243 offset:0
    ds_read_b128 v[212:215], v243 offset:1024
    s_add_u32 s53, s53, 8192
    s_cmp_ge_u32 s53, 24576
    s_cselect_b32 s53, 0, s53
    s_add_u32 s55, s36, s48
    s_add_u32 s36, s36, 34816
    s_cmp_ge_u32 s36, 139264
    s_cselect_b32 s40, 139264, 0
    s_sub_u32 s36, s36, s40
    s_waitcnt lgkmcnt(6)
    v_mfma_f32_16x16x32_bf16 v[64:67], v[224:227], v[192:195], v[64:67]
    ds_read_b64_tr_b16 v[236:237], v242 offset:328
    ds_read_b64_tr_b16 v[238:239], v242 offset:4680
    v_mfma_f32_16x16x32_bf16 v[68:71], v[224:227], v[196:199], v[68:71]
    s_waitcnt lgkmcnt(6)
    v_mfma_f32_16x16x32_bf16 v[72:75], v[228:231], v[192:195], v[72:75]
    ds_read_b64_tr_b16 v[224:225], v242 offset:384
    ds_read_b64_tr_b16 v[226:227], v242 offset:4736
    s_add_u32 s37, s52, s54
    s_add_u32 m0, s37, 0
    s_nop 0
    buffer_load_dwordx4 v247, s[8:11], s47 offen lds
    s_add_u32 s47, s47, 64
    s_add_u32 s54, s54, 8192
    s_cmp_ge_u32 s54, 24576
    s_cselect_b32 s54, 0, s54
    v_mfma_f32_16x16x32_bf16 v[76:79], v[228:231], v[196:199], v[76:79]
    s_waitcnt lgkmcnt(6)
    v_mfma_f32_16x16x32_bf16 v[80:83], v[232:235], v[192:195], v[80:83]
    ds_read_b64_tr_b16 v[228:229], v242 offset:392
    ds_read_b64_tr_b16 v[230:231], v242 offset:4744
    v_mfma_f32_16x16x32_bf16 v[84:87], v[232:235], v[196:199], v[84:87]
    s_add_u32 s38, s45, 0
    s_add_u32 m0, s55, 0
    s_nop 0
    buffer_load_dwordx4 v245, s[20:23], s38 offen lds
    s_waitcnt lgkmcnt(4)
    v_mfma_f32_16x16x32_bf16 v[88:91], v[236:239], v[192:195], v[88:91]
    ds_read_b64_tr_b16 v[232:233], v242 offset:448
    ds_read_b64_tr_b16 v[234:235], v242 offset:4800
    v_mfma_f32_16x16x32_bf16 v[92:95], v[236:239], v[196:199], v[92:95]
    s_waitcnt lgkmcnt(4)
    v_mfma_f32_16x16x32_bf16 v[96:99], v[224:227], v[192:195], v[96:99]
    ds_read_b64_tr_b16 v[236:237], v242 offset:456
    ds_read_b64_tr_b16 v[238:239], v242 offset:4808
    s_add_u32 s38, s45, 8192
    s_add_u32 m0, s55, 1088
    s_nop 0
    buffer_load_dwordx4 v245, s[20:23], s38 offen lds
    v_mfma_f32_16x16x32_bf16 v[100:103], v[224:227], v[196:199], v[100:103]
    s_waitcnt lgkmcnt(4)
    v_mfma_f32_16x16x32_bf16 v[104:107], v[228:231], v[192:195], v[104:107]
    s_add_u32 s35, s35, 34816
    s_cmp_ge_u32 s35, 139264
    s_cselect_b32 s40, 139264, 0
    s_sub_u32 s35, s35, s40
    v_add_u32 v242, s35, v240
    ds_read_b64_tr_b16 v[224:225], v242 offset:0
    ds_read_b64_tr_b16 v[226:227], v242 offset:4352
    v_mfma_f32_16x16x32_bf16 v[108:111], v[228:231], v[196:199], v[108:111]
    s_add_u32 s38, s45, 16384
    s_add_u32 m0, s55, 2176
    s_nop 0
    buffer_load_dwordx4 v245, s[20:23], s38 offen lds
    s_waitcnt lgkmcnt(4)
    v_mfma_f32_16x16x32_bf16 v[112:115], v[232:235], v[192:195], v[112:115]
    ds_read_b64_tr_b16 v[228:229], v242 offset:8
    ds_read_b64_tr_b16 v[230:231], v242 offset:4360
    v_mfma_f32_16x16x32_bf16 v[116:119], v[232:235], v[196:199], v[116:119]
    s_waitcnt lgkmcnt(4)
    v_mfma_f32_16x16x32_bf16 v[120:123], v[236:239], v[192:195], v[120:123]
    ds_read_b64_tr_b16 v[232:233], v242 offset:64
    ds_read_b64_tr_b16 v[234:235], v242 offset:4416
    s_add_u32 s38, s45, 24576
    s_add_u32 m0, s55, 3264
    s_nop 0
    buffer_load_dwordx4 v245, s[20:23], s38 offen lds
    s_add_u32 s45, s45, 262144
    v_mfma_f32_16x16x32_bf16 v[124:127], v[236:239], v[196:199], v[124:127]
    s_sub_u32 s41, s41, 1
    s_cmp_lg_u32 s41, 0
    s_cbranch_scc1 L_p1
    s_waitcnt lgkmcnt(4)
    v_mfma_f32_16x16x32_bf16 v[0:3], v[224:227], v[208:211], v[0:3]
    ds_read_b64_tr_b16 v[236:237], v242 offset:72
    ds_read_b64_tr_b16 v[238:239], v242 offset:4424
    v_mfma_f32_16x16x32_bf16 v[4:7], v[224:227], v[212:215], v[4:7]
    s_waitcnt lgkmcnt(4)
    v_mfma_f32_16x16x32_bf16 v[8:11], v[228:231], v[208:211], v[8:11]
    ds_read_b64_tr_b16 v[224:225], v242 offset:128
    ds_read_b64_tr_b16 v[226:227], v242 offset:4480
    v_mfma_f32_16x16x32_bf16 v[12:15], v[228:231], v[212:215], v[12:15]
    s_waitcnt lgkmcnt(4)
    v_mfma_f32_16x16x32_bf16 v[16:19], v[232:235], v[208:211], v[16:19]
    ds_read_b64_tr_b16 v[228:229], v242 offset:136
    ds_read_b64_tr_b16 v[230:231], v242 offset:4488
    v_mfma_f32_16x16x32_bf16 v[20:23], v[232:235], v[212:215], v[20:23]
    s_waitcnt lgkmcnt(4)
    v_mfma_f32_16x16x32_bf16 v[24:27], v[236:239], v[208:211], v[24:27]
    ds_read_b64_tr_b16 v[232:233], v242 offset:192
    ds_read_b64_tr_b16 v[234:235], v242 offset:4544
    v_mfma_f32_16x16x32_bf16 v[28:31], v[236:239], v[212:215], v[28:31]
    s_waitcnt lgkmcnt(4)
    v_mfma_f32_16x16x32_bf16 v[32:35], v[224:227], v[208:211], v[32:35]
    ds_read_b64_tr_b16 v[236:237], v242 offset:200
    ds_read_b64_tr_b16 v[238:239], v242 offset:4552
    v_mfma_f32_16x16x32_bf16 v[36:39], v[224:227], v[212:215], v[36:39]
    s_waitcnt lgkmcnt(4)
    v_mfma_f32_16x16x32_bf16 v[40:43], v[228:231], v[208:211], v[40:43]
    ds_read_b64_tr_b16 v[224:225], v242 offset:256
    ds_read_b64_tr_b16 v[226:227], v242 offset:4608
    v_mfma_f32_16x16x32_bf16 v[44:47], v[228:231], v[212:215], v[44:47]
    s_waitcnt lgkmcnt(4)
    v_mfma_f32_16x16x32_bf16 v[48:51], v[232:235], v[208:211], v[48:51]
    ds_read_b64_tr_b16 v[228:229], v242 offset:264
    ds_read_b64_tr_b16 v[230:231], v242 offset:4616
    v_mfma_f32_16x16x32_bf16 v[52:55], v[232:235], v[212:215], v[52:55]
    s_waitcnt lgkmcnt(4)
    v_mfma_f32_16x16x32_bf16 v[56:59], v[236:239], v[208:211], v[56:59]
    ds_read_b64_tr_b16 v[232:233], v242 offset:320
    ds_read_b64_tr_b16 v[234:235], v242 offset:4672
    v_mfma_f32_16x16x32_bf16 v[60:63], v[236:239], v[212:215], v[60:63]
    s_waitcnt vmcnt(4)
    s_barrier
    v_add_u32 v243, s53, v241
    ds_read_b128 v[192:195], v243 offset:0
    ds_read_b128 v[196:199], v243 offset:1024
    s_add_u32 s53, s53, 8192
    s_cmp_ge_u32 s53, 24576
    s_cselect_b32 s53, 0, s53
    s_mul_i32 s48, s32, 2112
    s_mul_i32 s49, s32, 2176
    s_add_u32 s49, s49, s90
    s_add_u32 s49, s49, 17408
    s_lshr_b32 s45, s2, 4
    s_xor_b32 s45, s45, s2
    s_and_b32 s45, s45, 15
    s_lshl_b32 s45, s45, 14
    s_lshl_b32 s46, s32, 11
    s_add_u32 s45, s45, s46
    s_mov_b32 s46, s45
    s_add_u32 s55, s36, s48
    s_add_u32 s78, s36, s49
    s_add_u32 s36, s36, 34816
    s_cmp_ge_u32 s36, 139264
    s_cselect_b32 s40, 139264, 0
    s_sub_u32 s36, s36, s40
    s_waitcnt lgkmcnt(6)
    v_mfma_f32_16x16x32_bf16 v[64:67], v[224:227], v[208:211], v[64:67]
    ds_read_b64_tr_b16 v[236:237], v242 offset:328
    ds_read_b64_tr_b16 v[238:239], v242 offset:4680
    v_mfma_f32_16x16x32_bf16 v[68:71], v[224:227], v[212:215], v[68:71]
    s_waitcnt lgkmcnt(6)
    v_mfma_f32_16x16x32_bf16 v[72:75], v[228:231], v[208:211], v[72:75]
    ds_read_b64_tr_b16 v[224:225], v242 offset:384
    ds_read_b64_tr_b16 v[226:227], v242 offset:4736
    s_add_u32 s37, s52, s54
    s_add_u32 m0, s37, 0
    s_nop 0
    buffer_load_dwordx4 v247, s[8:11], s47 offen lds
    s_add_u32 s47, s47, 64
    s_add_u32 s54, s54, 8192
    s_cmp_ge_u32 s54, 24576
    s_cselect_b32 s54, 0, s54
    v_mfma_f32_16x16x32_bf16 v[76:79], v[228:231], v[212:215], v[76:79]
    s_waitcnt lgkmcnt(6)
    v_mfma_f32_16x16x32_bf16 v[80:83], v[232:235], v[208:211], v[80:83]
    ds_read_b64_tr_b16 v[228:229], v242 offset:392
    ds_read_b64_tr_b16 v[230:231], v242 offset:4744
    v_mfma_f32_16x16x32_bf16 v[84:87], v[232:235], v[212:215], v[84:87]
    s_add_u32 m0, s55, 0
    s_nop 0
    buffer_load_dwordx4 v246, s[12:15], s45 offen nt lds
    s_waitcnt lgkmcnt(4)
    v_mfma_f32_16x16x32_bf16 v[88:91], v[236:239], v[208:211], v[88:91]
    ds_read_b64_tr_b16 v[232:233], v242 offset:448
    ds_read_b64_tr_b16 v[234:235], v242 offset:4800
    v_mfma_f32_16x16x32_bf16 v[92:95], v[236:239], v[212:215], v[92:95]
    s_waitcnt lgkmcnt(4)
    v_mfma_f32_16x16x32_bf16 v[96:99], v[224:227], v[208:211], v[96:99]
    ds_read_b64_tr_b16 v[236:237], v242 offset:456
    ds_read_b64_tr_b16 v[238:239], v242 offset:4808
    s_add_u32 m0, s55, 32
    s_nop 0
    buffer_load_dwordx4 v246, s[12:15], s45 offen offset:1024 nt lds
    s_add_u32 s45, s45, 16384
    s_and_b32 s45, s45, 0x3ffff
    v_mfma_f32_16x16x32_bf16 v[100:103], v[224:227], v[212:215], v[100:103]
    s_waitcnt lgkmcnt(4)
    v_mfma_f32_16x16x32_bf16 v[104:107], v[228:231], v[208:211], v[104:107]
    s_add_u32 s35, s35, 34816
    s_cmp_ge_u32 s35, 139264
    s_cselect_b32 s40, 139264, 0
    s_sub_u32 s35, s35, s40
    v_add_u32 v242, s35, v240
    ds_read_b64_tr_b16 v[224:225], v242 offset:0
    ds_read_b64_tr_b16 v[226:227], v242 offset:4352
    v_mfma_f32_16x16x32_bf16 v[108:111], v[228:231], v[212:215], v[108:111]
    s_waitcnt lgkmcnt(4)
    v_mfma_f32_16x16x32_bf16 v[112:115], v[232:235], v[208:211], v[112:115]
    ds_read_b64_tr_b16 v[228:229], v242 offset:8
    ds_read_b64_tr_b16 v[230:231], v242 offset:4360
    v_mfma_f32_16x16x32_bf16 v[116:119], v[232:235], v[212:215], v[116:119]
    s_waitcnt lgkmcnt(4)
    v_mfma_f32_16x16x32_bf16 v[120:123], v[236:239], v[208:211], v[120:123]
    ds_read_b64_tr_b16 v[232:233], v242 offset:64
    ds_read_b64_tr_b16 v[234:235], v242 offset:4416
    v_mfma_f32_16x16x32_bf16 v[124:127], v[236:239], v[212:215], v[124:127]
    s_waitcnt lgkmcnt(4)
    v_mfma_f32_16x16x32_bf16 v[0:3], v[224:227], v[192:195], v[0:3]
    ds_read_b64_tr_b16 v[236:237], v242 offset:72
    ds_read_b64_tr_b16 v[238:239], v242 offset:4424
    v_mfma_f32_16x16x32_bf16 v[4:7], v[224:227], v[196:199], v[4:7]
    s_waitcnt lgkmcnt(4)
    v_mfma_f32_16x16x32_bf16 v[8:11], v[228:231], v[192:195], v[8:11]
    ds_read_b64_tr_b16 v[224:225], v242 offset:128
    ds_read_b64_tr_b16 v[226:227], v242 offset:4480
    v_mfma_f32_16x16x32_bf16 v[12:15], v[228:231], v[196:199], v[12:15]
    s_waitcnt lgkmcnt(4)
    v_mfma_f32_16x16x32_bf16 v[16:19], v[232:235], v[192:195], v[16:19]
    ds_read_b64_tr_b16 v[228:229], v242 offset:136
    ds_read_b64_tr_b16 v[230:231], v242 offset:4488
    v_mfma_f32_16x16x32_bf16 v[20:23], v[232:235], v[196:199], v[20:23]
    s_waitcnt lgkmcnt(4)
    v_mfma_f32_16x16x32_bf16 v[24:27], v[236:239], v[192:195], v[24:27]
    ds_read_b64_tr_b16 v[232:233], v242 offset:192
    ds_read_b64_tr_b16 v[234:235], v242 offset:4544
    v_mfma_f32_16x16x32_bf16 v[28:31], v[236:239], v[196:199], v[28:31]
    s_waitcnt lgkmcnt(4)
    v_mfma_f32_16x16x32_bf16 v[32:35], v[224:227], v[192:195], v[32:35]
    ds_read_b64_tr_b16 v[236:237], v242 offset:200
    ds_read_b64_tr_b16 v[238:239], v242 offset:4552
    v_mfma_f32_16x16x32_bf16 v[36:39], v[224:227], v[196:199], v[36:39]
    s_waitcnt lgkmcnt(4)
    v_mfma_f32_16x16x32_bf16 v[40:43], v[228:231], v[192:195], v[40:43]
    ds_read_b64_tr_b16 v[224:225], v242 offset:256
    ds_read_b64_tr_b16 v[226:227], v242 offset:4608
    v_mfma_f32_16x16x32_bf16 v[44:47], v[228:231], v[196:199], v[44:47]
    s_waitcnt lgkmcnt(4)
    v_mfma_f32_16x16x32_bf16 v[48:51], v[232:235], v[192:195], v[48:51]
    ds_read_b64_tr_b16 v[228:229], v242 offset:264
    ds_read_b64_tr_b16 v[230:231], v242 offset:4616
    v_mfma_f32_16x16x32_bf16 v[52:55], v[232:235], v[196:199], v[52:55]
    s_waitcnt lgkmcnt(4)
    v_mfma_f32_16x16x32_bf16 v[56:59], v[236:239], v[192:195], v[56:59]
    ds_read_b64_tr_b16 v[232:233], v242 offset:320
    ds_read_b64_tr_b16 v[234:235], v242 offset:4672
    v_mfma_f32_16x16x32_bf16 v[60:63], v[236:239], v[196:199], v[60:63]
    s_waitcnt vmcnt(2)
    s_barrier
    v_add_u32 v243, s53, v241
    ds_read_b128 v[208:211], v243 offset:0
    ds_read_b128 v[212:215], v243 offset:1024
    s_add_u32 s53, s53, 8192
    s_cmp_ge_u32 s53, 24576
    s_cselect_b32 s53, 0, s53
    s_add_u32 s55, s36, s48
    s_add_u32 s78, s36, s49
    s_add_u32 s36, s36, 34816
    s_cmp_ge_u32 s36, 139264
    s_cselect_b32 s40, 139264, 0
    s_sub_u32 s36, s36, s40
    s_waitcnt lgkmcnt(6)
    v_mfma_f32_16x16x32_bf16 v[64:67], v[224:227], v[192:195], v[64:67]
    ds_read_b64_tr_b16 v[236:237], v242 offset:328
    ds_read_b64_tr_b16 v[238:239], v242 offset:4680
    v_mfma_f32_16x16x32_bf16 v[68:71], v[224:227], v[196:199], v[68:71]
    s_waitcnt lgkmcnt(6)
    v_mfma_f32_16x16x32_bf16 v[72:75], v[228:231], v[192:195], v[72:75]
    ds_read_b64_tr_b16 v[224:225], v242 offset:384
    ds_read_b64_tr_b16 v[226:227], v242 offset:4736
    s_add_u32 m0, s55, 0
    s_nop 0
    buffer_load_dwordx4 v246, s[12:15], s45 offen nt lds
    v_mfma_f32_16x16x32_bf16 v[76:79], v[228:231], v[196:199], v[76:79]
    s_waitcnt lgkmcnt(6)
    v_mfma_f32_16x16x32_bf16 v[80:83], v[232:235], v[192:195], v[80:83]
    ds_read_b64_tr_b16 v[228:229], v242 offset:392
    ds_read_b64_tr_b16 v[230:231], v242 offset:4744
    v_mfma_f32_16x16x32_bf16 v[84:87], v[232:235], v[196:199], v[84:87]
    s_add_u32 m0, s55, 32
    s_nop 0
    buffer_load_dwordx4 v246, s[12:15], s45 offen offset:1024 nt lds
    s_add_u32 s45, s45, 16384
    s_and_b32 s45, s45, 0x3ffff
    s_waitcnt lgkmcnt(4)
    v_mfma_f32_16x16x32_bf16 v[88:91], v[236:239], v[192:195], v[88:91]
    ds_read_b64_tr_b16 v[232:233], v242 offset:448
    ds_read_b64_tr_b16 v[234:235], v242 offset:4800
    v_mfma_f32_16x16x32_bf16 v[92:95], v[236:239], v[196:199], v[92:95]
    s_waitcnt lgkmcnt(4)
    v_mfma_f32_16x16x32_bf16 v[96:99], v[224:227], v[192:195], v[96:99]
    ds_read_b64_tr_b16 v[236:237], v242 offset:456
    ds_read_b64_tr_b16 v[238:239], v242 offset:4808
    s_add_u32 m0, s78, 0
    s_nop 0
    buffer_load_dwordx4 v245, s[16:19], s46 offen nt lds
    v_mfma_f32_16x16x32_bf16 v[100:103], v[224:227], v[196:199], v[100:103]
    s_waitcnt lgkmcnt(4)
    v_mfma_f32_16x16x32_bf16 v[104:107], v[228:231], v[192:195], v[104:107]
    s_add_u32 s35, s35, 34816
    s_cmp_ge_u32 s35, 139264
    s_cselect_b32 s40, 139264, 0
    s_sub_u32 s35, s35, s40
    v_add_u32 v242, s35, v240
    ds_read_b64_tr_b16 v[224:225], v242 offset:0
    ds_read_b64_tr_b16 v[226:227], v242 offset:4352
    v_mfma_f32_16x16x32_bf16 v[108:111], v[228:231], v[196:199], v[108:111]
    s_add_u32 m0, s78, 64
    s_nop 0
    buffer_load_dwordx4 v245, s[16:19], s46 offen offset:1024 nt lds
    s_add_u32 s46, s46, 16384
    s_and_b32 s46, s46, 0x3ffff
    s_waitcnt lgkmcnt(4)
    v_mfma_f32_16x16x32_bf16 v[112:115], v[232:235], v[192:195], v[112:115]
    ds_read_b64_tr_b16 v[228:229], v242 offset:8
    ds_read_b64_tr_b16 v[230:231], v242 offset:4360
    v_mfma_f32_16x16x32_bf16 v[116:119], v[232:235], v[196:199], v[116:119]
    s_waitcnt lgkmcnt(4)
    v_mfma_f32_16x16x32_bf16 v[120:123], v[236:239], v[192:195], v[120:123]
    ds_read_b64_tr_b16 v[232:233], v242 offset:64
    ds_read_b64_tr_b16 v[234:235], v242 offset:4416
    v_mfma_f32_16x16x32_bf16 v[124:127], v[236:239], v[196:199], v[124:127]
    s_waitcnt lgkmcnt(4)
    v_mfma_f32_16x16x32_bf16 v[0:3], v[224:227], v[208:211], v[0:3]
    ds_read_b64_tr_b16 v[236:237], v242 offset:72
    ds_read_b64_tr_b16 v[238:239], v242 offset:4424
    v_mfma_f32_16x16x32_bf16 v[4:7], v[224:227], v[212:215], v[4:7]
    s_waitcnt lgkmcnt(4)
    v_mfma_f32_16x16x32_bf16 v[8:11], v[228:231], v[208:211], v[8:11]
    ds_read_b64_tr_b16 v[224:225], v242 offset:128
    ds_read_b64_tr_b16 v[226:227], v242 offset:4480
    v_mfma_f32_16x16x32_bf16 v[12:15], v[228:231], v[212:215], v[12:15]
    s_waitcnt lgkmcnt(4)
    v_mfma_f32_16x16x32_bf16 v[16:19], v[232:235], v[208:211], v[16:19]
    ds_read_b64_tr_b16 v[228:229], v242 offset:136
    ds_read_b64_tr_b16 v[230:231], v242 offset:4488
    v_mfma_f32_16x16x32_bf16 v[20:23], v[232:235], v[212:215], v[20:23]
    s_waitcnt lgkmcnt(4)
    v_mfma_f32_16x16x32_bf16 v[24:27], v[236:239], v[208:211], v[24:27]
    ds_read_b64_tr_b16 v[232:233], v242 offset:192
    ds_read_b64_tr_b16 v[234:235], v242 offset:4544
    v_mfma_f32_16x16x32_bf16 v[28:31], v[236:239], v[212:215], v[28:31]
    s_waitcnt lgkmcnt(4)
    v_mfma_f32_16x16x32_bf16 v[32:35], v[224:227], v[208:211], v[32:35]
    ds_read_b64_tr_b16 v[236:237], v242 offset:200
    ds_read_b64_tr_b16 v[238:239], v242 offset:4552
    v_mfma_f32_16x16x32_bf16 v[36:39], v[224:227], v[212:215], v[36:39]
    s_waitcnt lgkmcnt(4)
    v_mfma_f32_16x16x32_bf16 v[40:43], v[228:231], v[208:211], v[40:43]
    ds_read_b64_tr_b16 v[224:225], v242 offset:256
    ds_read_b64_tr_b16 v[226:227], v242 offset:4608
    v_mfma_f32_16x16x32_bf16 v[44:47], v[228:231], v[212:215], v[44:47]
    s_waitcnt lgkmcnt(4)
    v_mfma_f32_16x16x32_bf16 v[48:51], v[232:235], v[208:211], v[48:51]
    ds_read_b64_tr_b16 v[228:229], v242 offset:264
    ds_read_b64_tr_b16 v[230:231], v242 offset:4616
    v_mfma_f32_16x16x32_bf16 v[52:55], v[232:235], v[212:215], v[52:55]
    s_waitcnt lgkmcnt(4)
    v_mfma_f32_16x16x32_bf16 v[56:59], v[236:239], v[208:211], v[56:59]
    ds_read_b64_tr_b16 v[232:233], v242 offset:320
    ds_read_b64_tr_b16 v[234:235], v242 offset:4672
    v_mfma_f32_16x16x32_bf16 v[60:63], v[236:239], v[212:215], v[60:63]
    s_waitcnt vmcnt(4)
    s_barrier
    s_add_u32 s55, s36, s48
    s_add_u32 s78, s36, s49
    s_add_u32 s36, s36, 34816
    s_cmp_ge_u32 s36, 139264
    s_cselect_b32 s40, 139264, 0
    s_sub_u32 s36, s36, s40
    s_waitcnt lgkmcnt(4)
    v_mfma_f32_16x16x32_bf16 v[64:67], v[224:227], v[208:211], v[64:67]
    ds_read_b64_tr_b16 v[236:237], v242 offset:328
    ds_read_b64_tr_b16 v[238:239], v242 offset:4680
    v_mfma_f32_16x16x32_bf16 v[68:71], v[224:227], v[212:215], v[68:71]
    s_waitcnt lgkmcnt(4)
    v_mfma_f32_16x16x32_bf16 v[72:75], v[228:231], v[208:211], v[72:75]
    ds_read_b64_tr_b16 v[224:225], v242 offset:384
    ds_read_b64_tr_b16 v[226:227], v242 offset:4736
    s_add_u32 m0, s55, 0
    s_nop 0
    buffer_load_dwordx4 v246, s[12:15], s45 offen nt lds
    v_mfma_f32_16x16x32_bf16 v[76:79], v[228:231], v[212:215], v[76:79]
    s_waitcnt lgkmcnt(4)
    v_mfma_f32_16x16x32_bf16 v[80:83], v[232:235], v[208:211], v[80:83]
    ds_read_b64_tr_b16 v[228:229], v242 offset:392
    ds_read_b64_tr_b16 v[230:231], v242 offset:4744
    v_mfma_f32_16x16x32_bf16 v[84:87], v[232:235], v[212:215], v[84:87]
    s_add_u32 m0, s55, 32
    s_nop 0
    buffer_load_dwordx4 v246, s[12:15], s45 offen offset:1024 nt lds
    s_add_u32 s45, s45, 16384
    s_and_b32 s45, s45, 0x3ffff
    s_waitcnt lgkmcnt(4)
    v_mfma_f32_16x16x32_bf16 v[88:91], v[236:239], v[208:211], v[88:91]
    ds_read_b64_tr_b16 v[232:233], v242 offset:448
    ds_read_b64_tr_b16 v[234:235], v242 offset:4800
    v_mfma_f32_16x16x32_bf16 v[92:95], v[236:239], v[212:215], v[92:95]
    s_waitcnt lgkmcnt(4)
    v_mfma_f32_16x16x32_bf16 v[96:99], v[224:227], v[208:211], v[96:99]
    ds_read_b64_tr_b16 v[236:237], v242 offset:456
    ds_read_b64_tr_b16 v[238:239], v242 offset:4808
    s_add_u32 m0, s78, 0
    s_nop 0
    buffer_load_dwordx4 v245, s[16:19], s46 offen nt lds
    v_mfma_f32_16x16x32_bf16 v[100:103], v[224:227], v[212:215], v[100:103]
    s_waitcnt lgkmcnt(4)
    v_mfma_f32_16x16x32_bf16 v[104:107], v[228:231], v[208:211], v[104:107]
    v_and_b32 v252, 15, v255
    v_mul_u32_u24 v252, 1056, v252
    v_lshrrev_b32 v253, 4, v255
    v_lshl_add_u32 v240, v253, 4, v252
    v_bfe_u32 v252, v255, 2, 2
    v_lshl_add_u32 v252, v253, 2, v252
    v_mul_u32_u24 v252, 1088, v252
    v_and_b32 v253, 1, v253
    v_lshl_add_u32 v252, v253, 3, v252
    v_and_b32 v253, 3, v255
    v_lshl_add_u32 v252, v253, 4, v252
    v_add_u32 v241, 17408, v252
    s_add_u32 s35, s35, 34816
    s_cmp_ge_u32 s35, 139264
    s_cselect_b32 s40, 139264, 0
    s_sub_u32 s35, s35, s40
    v_add_u32 v242, s35, v240
    v_xor_b32 v244, 16, v242
    v_add_u32 v243, s35, v241
    ds_read_b128 v[224:227], v242 offset:0
    v_mfma_f32_16x16x32_bf16 v[108:111], v[228:231], v[212:215], v[108:111]
    s_add_u32 m0, s78, 64
    s_nop 0
    buffer_load_dwordx4 v245, s[16:19], s46 offen offset:1024 nt lds
    s_add_u32 s46, s46, 16384
    s_and_b32 s46, s46, 0x3ffff
    s_waitcnt lgkmcnt(3)
    v_mfma_f32_16x16x32_bf16 v[112:115], v[232:235], v[208:211], v[112:115]
    ds_read_b128 v[228:231], v244 offset:512
    v_mfma_f32_16x16x32_bf16 v[116:119], v[232:235], v[212:215], v[116:119]
    s_waitcnt lgkmcnt(2)
    v_mfma_f32_16x16x32_bf16 v[120:123], v[236:239], v[208:211], v[120:123]
    ds_read_b128 v[232:235], v242 offset:64
    v_mfma_f32_16x16x32_bf16 v[124:127], v[236:239], v[212:215], v[124:127]
    v_cvt_pk_bf16_f32 v128, v0, v1
    v_cvt_pk_bf16_f32 v129, v2, v3
    v_cvt_pk_bf16_f32 v130, v8, v9
    v_cvt_pk_bf16_f32 v131, v10, v11
    v_cvt_pk_bf16_f32 v160, v4, v5
    v_cvt_pk_bf16_f32 v161, v6, v7
    v_cvt_pk_bf16_f32 v162, v12, v13
    v_cvt_pk_bf16_f32 v163, v14, v15
    v_cvt_pk_bf16_f32 v132, v16, v17
    v_cvt_pk_bf16_f32 v133, v18, v19
    v_cvt_pk_bf16_f32 v134, v24, v25
    v_cvt_pk_bf16_f32 v135, v26, v27
    v_cvt_pk_bf16_f32 v164, v20, v21
    v_cvt_pk_bf16_f32 v165, v22, v23
    v_cvt_pk_bf16_f32 v166, v28, v29
    v_cvt_pk_bf16_f32 v167, v30, v31
    v_cvt_pk_bf16_f32 v136, v32, v33
    v_cvt_pk_bf16_f32 v137, v34, v35
    v_cvt_pk_bf16_f32 v138, v40, v41
    v_cvt_pk_bf16_f32 v139, v42, v43
    v_cvt_pk_bf16_f32 v168, v36, v37
    v_cvt_pk_bf16_f32 v169, v38, v39
    v_cvt_pk_bf16_f32 v170, v44, v45
    v_cvt_pk_bf16_f32 v171, v46, v47
    v_cvt_pk_bf16_f32 v140, v48, v49
    v_cvt_pk_bf16_f32 v141, v50, v51
    v_cvt_pk_bf16_f32 v142, v56, v57
    v_cvt_pk_bf16_f32 v143, v58, v59
    v_cvt_pk_bf16_f32 v172, v52, v53
    v_cvt_pk_bf16_f32 v173, v54, v55
    v_cvt_pk_bf16_f32 v174, v60, v61
    v_cvt_pk_bf16_f32 v175, v62, v63
    v_cvt_pk_bf16_f32 v144, v64, v65
    v_cvt_pk_bf16_f32 v145, v66, v67
    v_cvt_pk_bf16_f32 v146, v72, v73
    v_cvt_pk_bf16_f32 v147, v74, v75
    v_cvt_pk_bf16_f32 v176, v68, v69
    v_cvt_pk_bf16_f32 v177, v70, v71
    v_cvt_pk_bf16_f32 v178, v76, v77
    v_cvt_pk_bf16_f32 v179, v78, v79
    v_cvt_pk_bf16_f32 v148, v80, v81
    v_cvt_pk_bf16_f32 v149, v82, v83
    v_cvt_pk_bf16_f32 v150, v88, v89
    v_cvt_pk_bf16_f32 v151, v90, v91
    v_cvt_pk_bf16_f32 v180, v84, v85
    v_cvt_pk_bf16_f32 v181, v86, v87
    v_cvt_pk_bf16_f32 v182, v92, v93
    v_cvt_pk_bf16_f32 v183, v94, v95
    v_cvt_pk_bf16_f32 v152, v96, v97
    v_cvt_pk_bf16_f32 v153, v98, v99
    v_cvt_pk_bf16_f32 v154, v104, v105
    v_cvt_pk_bf16_f32 v155, v106, v107
    v_cvt_pk_bf16_f32 v184, v100, v101
    v_cvt_pk_bf16_f32 v185, v102, v103
    v_cvt_pk_bf16_f32 v186, v108, v109
    v_cvt_pk_bf16_f32 v187, v110, v111
    v_cvt_pk_bf16_f32 v156, v112, v113
    v_cvt_pk_bf16_f32 v157, v114, v115
    v_cvt_pk_bf16_f32 v158, v120, v121
    v_cvt_pk_bf16_f32 v159, v122, v123
    v_cvt_pk_bf16_f32 v188, v116, v117
    v_cvt_pk_bf16_f32 v189, v118, v119
    v_cvt_pk_bf16_f32 v190, v124, v125
    v_cvt_pk_bf16_f32 v191, v126, v127
    v_mov_b32 v250, 0
    v_mov_b32 v251, 0
    s_waitcnt lgkmcnt(2)
    v_mfma_f32_16x16x32_bf16 v[192:195], v[224:227], v[128:131], 0
    ds_read_b128 v[236:239], v244 offset:576
    v_mfma_f32_16x16x32_bf16 v[200:203], v[224:227], v[160:163], 0
    s_waitcnt lgkmcnt(2)
    v_mfma_f32_16x16x32_bf16 v[196:199], v[228:231], v[128:131], 0
    ds_read_b128 v[224:227], v242 offset:128
    v_mfma_f32_16x16x32_bf16 v[204:207], v[228:231], v[160:163], 0
    s_waitcnt lgkmcnt(2)
    v_mfma_f32_16x16x32_bf16 v[192:195], v[232:235], v[132:135], v[192:195]
    ds_read_b128 v[228:231], v244 offset:640
    v_mfma_f32_16x16x32_bf16 v[200:203], v[232:235], v[164:167], v[200:203]
    s_waitcnt lgkmcnt(2)
    v_mfma_f32_16x16x32_bf16 v[196:199], v[236:239], v[132:135], v[196:199]
    ds_read_b128 v[232:235], v242 offset:192
    v_mfma_f32_16x16x32_bf16 v[204:207], v[236:239], v[164:167], v[204:207]
    s_waitcnt vmcnt(4)
    s_barrier
    s_add_u32 s55, s36, s48
    s_add_u32 s78, s36, s49
    s_add_u32 s36, s36, 34816
    s_cmp_ge_u32 s36, 139264
    s_cselect_b32 s40, 139264, 0
    s_sub_u32 s36, s36, s40
    s_waitcnt lgkmcnt(2)
    v_mfma_f32_16x16x32_bf16 v[192:195], v[224:227], v[136:139], v[192:195]
    ds_read_b128 v[236:239], v244 offset:704
    v_mfma_f32_16x16x32_bf16 v[200:203], v[224:227], v[168:171], v[200:203]
    s_waitcnt lgkmcnt(2)
    v_mfma_f32_16x16x32_bf16 v[196:199], v[228:231], v[136:139], v[196:199]
    ds_read_b128 v[224:227], v242 offset:256
    v_mfma_f32_16x16x32_bf16 v[204:207], v[228:231], v[168:171], v[204:207]
    s_waitcnt lgkmcnt(2)
    v_mfma_f32_16x16x32_bf16 v[192:195], v[232:235], v[140:143], v[192:195]
    ds_read_b128 v[228:231], v244 offset:768
    s_add_u32 m0, s55, 0
    s_nop 0
    buffer_load_dwordx4 v246, s[12:15], s45 offen nt lds
    v_mfma_f32_16x16x32_bf16 v[200:203], v[232:235], v[172:175], v[200:203]
    s_waitcnt lgkmcnt(2)
    v_mfma_f32_16x16x32_bf16 v[196:199], v[236:239], v[140:143], v[196:199]
    ds_read_b128 v[232:235], v242 offset:320
    v_mfma_f32_16x16x32_bf16 v[204:207], v[236:239], v[172:175], v[204:207]
    s_waitcnt lgkmcnt(2)
    v_mfma_f32_16x16x32_bf16 v[192:195], v[224:227], v[144:147], v[192:195]
    ds_read_b128 v[236:239], v244 offset:832
    v_mfma_f32_16x16x32_bf16 v[200:203], v[224:227], v[176:179], v[200:203]
    s_add_u32 m0, s55, 32
    s_nop 0
    buffer_load_dwordx4 v246, s[12:15], s45 offen offset:1024 nt lds
    s_add_u32 s45, s45, 16384
    s_and_b32 s45, s45, 0x3ffff
    s_waitcnt lgkmcnt(2)
    v_mfma_f32_16x16x32_bf16 v[196:199], v[228:231], v[144:147], v[196:199]
    ds_read_b128 v[224:227], v242 offset:384
    v_mfma_f32_16x16x32_bf16 v[204:207], v[228:231], v[176:179], v[204:207]
    s_waitcnt lgkmcnt(2)
    v_mfma_f32_16x16x32_bf16 v[192:195], v[232:235], v[148:151], v[192:195]
    ds_read_b128 v[228:231], v244 offset:896
    v_mfma_f32_16x16x32_bf16 v[200:203], v[232:235], v[180:183], v[200:203]
    s_waitcnt lgkmcnt(2)
    v_mfma_f32_16x16x32_bf16 v[196:199], v[236:239], v[148:151], v[196:199]
    ds_read_b128 v[232:235], v242 offset:448
    s_add_u32 m0, s78, 0
    s_nop 0
    buffer_load_dwordx4 v245, s[16:19], s46 offen nt lds
    v_mfma_f32_16x16x32_bf16 v[204:207], v[236:239], v[180:183], v[204:207]
    s_waitcnt lgkmcnt(2)
    v_mfma_f32_16x16x32_bf16 v[192:195], v[224:227], v[152:155], v[192:195]
    ds_read_b128 v[236:239], v244 offset:960
    v_mfma_f32_16x16x32_bf16 v[200:203], v[224:227], v[184:187], v[200:203]
    s_waitcnt lgkmcnt(2)
    v_mfma_f32_16x16x32_bf16 v[196:199], v[228:231], v[152:155], v[196:199]
    s_add_u32 s35, s35, 34816
    s_cmp_ge_u32 s35, 139264
    s_cselect_b32 s40, 139264, 0
    s_sub_u32 s35, s35, s40
    v_add_u32 v242, s35, v240
    v_xor_b32 v244, 16, v242
    v_add_u32 v243, s35, v241
    ds_read_b128 v[224:227], v242 offset:0
    v_mfma_f32_16x16x32_bf16 v[204:207], v[228:231], v[184:187], v[204:207]
    s_add_u32 m0, s78, 64
    s_nop 0
    buffer_load_dwordx4 v245, s[16:19], s46 offen offset:1024 nt lds
    s_add_u32 s46, s46, 16384
    s_and_b32 s46, s46, 0x3ffff
    s_waitcnt lgkmcnt(2)
    v_mfma_f32_16x16x32_bf16 v[192:195], v[232:235], v[156:159], v[192:195]
    ds_read_b128 v[228:231], v244 offset:512
    v_mfma_f32_16x16x32_bf16 v[200:203], v[232:235], v[188:191], v[200:203]
    s_waitcnt lgkmcnt(2)
    v_mfma_f32_16x16x32_bf16 v[196:199], v[236:239], v[156:159], v[196:199]
    ds_read_b128 v[232:235], v242 offset:64
    v_mfma_f32_16x16x32_bf16 v[204:207], v[236:239], v[188:191], v[204:207]
    v_lshlrev_b32 v252, 6, v255
    s_mul_i32 s37, s79, 28672
    s_lshl_b32 s38, s32, 12
    s_add_u32 s37, s37, s38
    s_lshl_b32 s38, s32, 8
    s_add_u32 m0, s38, 139264
    s_nop 0
    buffer_load_dword v252, s[24:27], s37 offen lds
    v_max3_f32 v252, v192, v193, v194
    v_max3_f32 v252, v252, v195, v196
    v_max3_f32 v252, v252, v197, v198
    v_max_f32 v252, v252, v199
    v_max3_f32 v253, v200, v201, v202
    v_max3_f32 v253, v253, v203, v204
    v_max3_f32 v253, v253, v205, v206
    v_max_f32 v253, v253, v207
    v_mov_b32 v254, v252
    s_nop 1
    v_permlane16_swap_b32 v252, v254
    v_max_f32 v252, v252, v254
    v_mov_b32 v254, v252
    s_nop 1
    v_permlane32_swap_b32 v252, v254
    v_max_f32 v252, v252, v254
    v_mul_f32 v248, s43, v252
    v_mov_b32 v254, v253
    s_nop 1
    v_permlane16_swap_b32 v253, v254
    v_max_f32 v253, v253, v254
    v_mov_b32 v254, v253
    s_nop 1
    v_permlane32_swap_b32 v253, v254
    v_max_f32 v253, v253, v254
    v_mul_f32 v249, s43, v253
    s_waitcnt lgkmcnt(2)
    v_mfma_f32_16x16x32_bf16 v[208:211], v[224:227], v[128:131], 0
    ds_read_b128 v[236:239], v244 offset:576
    v_fma_f32 v192, v192, s42, v248
    v_fma_f32 v193, v193, s42, v248
    v_mfma_f32_16x16x32_bf16 v[216:219], v[224:227], v[160:163], 0
    v_exp_f32 v192, v192
    v_exp_f32 v193, v193
    s_waitcnt lgkmcnt(2)
    v_mfma_f32_16x16x32_bf16 v[212:215], v[228:231], v[128:131], 0
    ds_read_b128 v[224:227], v242 offset:128
    v_add_f32 v250, v250, v192
    v_add_f32 v250, v250, v193
    v_mfma_f32_16x16x32_bf16 v[220:223], v[228:231], v[160:163], 0
    v_cvt_pk_bf16_f32 v192, v192, v193
    v_fma_f32 v194, v194, s42, v248
    s_waitcnt lgkmcnt(2)
    v_mfma_f32_16x16x32_bf16 v[208:211], v[232:235], v[132:135], v[208:211]
    ds_read_b128 v[228:231], v244 offset:640
    v_fma_f32 v195, v195, s42, v248
    v_exp_f32 v194, v194
    v_mfma_f32_16x16x32_bf16 v[216:219], v[232:235], v[164:167], v[216:219]
    v_exp_f32 v195, v195
    s_waitcnt lgkmcnt(2)
    v_mfma_f32_16x16x32_bf16 v[212:215], v[236:239], v[132:135], v[212:215]
    ds_read_b128 v[232:235], v242 offset:192
    v_add_f32 v250, v250, v194
    v_add_f32 v250, v250, v195
    v_mfma_f32_16x16x32_bf16 v[220:223], v[236:239], v[164:167], v[220:223]
    v_cvt_pk_bf16_f32 v193, v194, v195
    v_fma_f32 v196, v196, s42, v248
    s_waitcnt lgkmcnt(2)
    v_mfma_f32_16x16x32_bf16 v[208:211], v[224:227], v[136:139], v[208:211]
    ds_read_b128 v[236:239], v244 offset:704
    v_fma_f32 v197, v197, s42, v248
    v_exp_f32 v196, v196
    v_mfma_f32_16x16x32_bf16 v[216:219], v[224:227], v[168:171], v[216:219]
    v_exp_f32 v197, v197
    v_add_f32 v250, v250, v196
    s_waitcnt lgkmcnt(2)
    v_mfma_f32_16x16x32_bf16 v[212:215], v[228:231], v[136:139], v[212:215]
    ds_read_b128 v[224:227], v242 offset:256
    v_add_f32 v250, v250, v197
    v_mfma_f32_16x16x32_bf16 v[220:223], v[228:231], v[168:171], v[220:223]
    v_cvt_pk_bf16_f32 v194, v196, v197
    v_fma_f32 v198, v198, s42, v248
    s_waitcnt lgkmcnt(2)
    v_mfma_f32_16x16x32_bf16 v[208:211], v[232:235], v[140:143], v[208:211]
    ds_read_b128 v[228:231], v244 offset:768
    v_fma_f32 v199, v199, s42, v248
    v_exp_f32 v198, v198
    v_mfma_f32_16x16x32_bf16 v[216:219], v[232:235], v[172:175], v[216:219]
    v_exp_f32 v199, v199
    v_add_f32 v250, v250, v198
    s_waitcnt lgkmcnt(2)
    v_mfma_f32_16x16x32_bf16 v[212:215], v[236:239], v[140:143], v[212:215]
    ds_read_b128 v[232:235], v242 offset:320
    v_add_f32 v250, v250, v199
    v_cvt_pk_bf16_f32 v195, v198, v199
    v_mfma_f32_16x16x32_bf16 v[220:223], v[236:239], v[172:175], v[220:223]
    v_fma_f32 v200, v200, s42, v249
    s_waitcnt lgkmcnt(2)
    v_mfma_f32_16x16x32_bf16 v[208:211], v[224:227], v[144:147], v[208:211]
    ds_read_b128 v[236:239], v244 offset:832
    v_fma_f32 v201, v201, s42, v249
    v_exp_f32 v200, v200
    v_mfma_f32_16x16x32_bf16 v[216:219], v[224:227], v[176:179], v[216:219]
    v_exp_f32 v201, v201
    v_add_f32 v251, v251, v200
    s_waitcnt lgkmcnt(2)
    v_mfma_f32_16x16x32_bf16 v[212:215], v[228:231], v[144:147], v[212:215]
    ds_read_b128 v[224:227], v242 offset:384
    v_add_f32 v251, v251, v201
    v_cvt_pk_bf16_f32 v200, v200, v201
    v_mfma_f32_16x16x32_bf16 v[220:223], v[228:231], v[176:179], v[220:223]
    v_fma_f32 v202, v202, s42, v249
    v_fma_f32 v203, v203, s42, v249
    s_waitcnt lgkmcnt(2)
    v_mfma_f32_16x16x32_bf16 v[208:211], v[232:235], v[148:151], v[208:211]
    ds_read_b128 v[228:231], v244 offset:896
    v_exp_f32 v202, v202
    v_mfma_f32_16x16x32_bf16 v[216:219], v[232:235], v[180:183], v[216:219]
    v_exp_f32 v203, v203
    v_add_f32 v251, v251, v202
    s_waitcnt lgkmcnt(2)
    v_mfma_f32_16x16x32_bf16 v[212:215], v[236:239], v[148:151], v[212:215]
    ds_read_b128 v[232:235], v242 offset:448
    v_add_f32 v251, v251, v203
    v_cvt_pk_bf16_f32 v201, v202, v203
    v_mfma_f32_16x16x32_bf16 v[220:223], v[236:239], v[180:183], v[220:223]
    v_fma_f32 v204, v204, s42, v249
    v_fma_f32 v205, v205, s42, v249
    s_waitcnt lgkmcnt(2)
    v_mfma_f32_16x16x32_bf16 v[208:211], v[224:227], v[152:155], v[208:211]
    ds_read_b128 v[236:239], v244 offset:960
    v_exp_f32 v204, v204
    v_exp_f32 v205, v205
    v_mfma_f32_16x16x32_bf16 v[216:219], v[224:227], v[184:187], v[216:219]
    v_add_f32 v251, v251, v204
    s_waitcnt lgkmcnt(2)
    v_mfma_f32_16x16x32_bf16 v[212:215], v[228:231], v[152:155], v[212:215]
    ds_read_b64_tr_b16 v[224:225], v243 offset:0
    ds_read_b64_tr_b16 v[226:227], v243 offset:512
    v_add_f32 v251, v251, v205
    v_cvt_pk_bf16_f32 v202, v204, v205
    v_mfma_f32_16x16x32_bf16 v[220:223], v[228:231], v[184:187], v[220:223]
    v_fma_f32 v206, v206, s42, v249
    v_fma_f32 v207, v207, s42, v249
    s_waitcnt lgkmcnt(3)
    v_mfma_f32_16x16x32_bf16 v[208:211], v[232:235], v[156:159], v[208:211]
    ds_read_b64_tr_b16 v[228:229], v243 offset:8
    ds_read_b64_tr_b16 v[230:231], v243 offset:520
    v_exp_f32 v206, v206
    v_exp_f32 v207, v207
    v_mfma_f32_16x16x32_bf16 v[216:219], v[232:235], v[188:191], v[216:219]
    v_add_f32 v251, v251, v206
    v_add_f32 v251, v251, v207
    s_waitcnt lgkmcnt(4)
    v_mfma_f32_16x16x32_bf16 v[212:215], v[236:239], v[156:159], v[212:215]
    ds_read_b64_tr_b16 v[232:233], v243 offset:64
    ds_read_b64_tr_b16 v[234:235], v243 offset:576
    v_cvt_pk_bf16_f32 v203, v206, v207
    v_mfma_f32_16x16x32_bf16 v[220:223], v[236:239], v[188:191], v[220:223]
    s_waitcnt lgkmcnt(4)
    v_mfma_f32_16x16x32_bf16 v[0:3], v[224:227], v[192:195], 0
    ds_read_b64_tr_b16 v[236:237], v243 offset:72
    ds_read_b64_tr_b16 v[238:239], v243 offset:584
    v_mfma_f32_16x16x32_bf16 v[4:7], v[224:227], v[200:203], 0
    s_waitcnt lgkmcnt(4)
    v_mfma_f32_16x16x32_bf16 v[8:11], v[228:231], v[192:195], 0
    ds_read_b64_tr_b16 v[224:225], v243 offset:128
    ds_read_b64_tr_b16 v[226:227], v243 offset:640
    v_mfma_f32_16x16x32_bf16 v[12:15], v[228:231], v[200:203], 0
    s_waitcnt lgkmcnt(4)
    v_mfma_f32_16x16x32_bf16 v[16:19], v[232:235], v[192:195], 0
    ds_read_b64_tr_b16 v[228:229], v243 offset:136
    ds_read_b64_tr_b16 v[230:231], v243 offset:648
    v_mfma_f32_16x16x32_bf16 v[20:23], v[232:235], v[200:203], 0
    s_waitcnt lgkmcnt(4)
    v_mfma_f32_16x16x32_bf16 v[24:27], v[236:239], v[192:195], 0
    ds_read_b64_tr_b16 v[232:233], v243 offset:192
    ds_read_b64_tr_b16 v[234:235], v243 offset:704
    v_mfma_f32_16x16x32_bf16 v[28:31], v[236:239], v[200:203], 0
    s_waitcnt vmcnt(4)
    s_barrier
    s_add_u32 s55, s36, s48
    s_add_u32 s78, s36, s49
    s_add_u32 s36, s36, 34816
    s_cmp_ge_u32 s36, 139264
    s_cselect_b32 s40, 139264, 0
    s_sub_u32 s36, s36, s40
    s_waitcnt lgkmcnt(4)
    v_mfma_f32_16x16x32_bf16 v[32:35], v[224:227], v[192:195], 0
    ds_read_b64_tr_b16 v[236:237], v243 offset:200
    ds_read_b64_tr_b16 v[238:239], v243 offset:712
    v_mfma_f32_16x16x32_bf16 v[36:39], v[224:227], v[200:203], 0
    s_waitcnt lgkmcnt(4)
    v_mfma_f32_16x16x32_bf16 v[40:43], v[228:231], v[192:195], 0
    ds_read_b64_tr_b16 v[224:225], v243 offset:256
    ds_read_b64_tr_b16 v[226:227], v243 offset:768
    v_max3_f32 v252, v208, v209, v210
    v_mfma_f32_16x16x32_bf16 v[44:47], v[228:231], v[200:203], 0
    v_max3_f32 v252, v252, v211, v212
    s_waitcnt lgkmcnt(4)
    v_mfma_f32_16x16x32_bf16 v[48:51], v[232:235], v[192:195], 0
    ds_read_b64_tr_b16 v[228:229], v243 offset:264
    ds_read_b64_tr_b16 v[230:231], v243 offset:776
    s_add_u32 m0, s55, 0
    s_nop 0
    buffer_load_dwordx4 v246, s[12:15], s45 offen nt lds
    v_max3_f32 v252, v252, v213, v214
    v_mfma_f32_16x16x32_bf16 v[52:55], v[232:235], v[200:203], 0
    s_waitcnt lgkmcnt(4)
    v_mfma_f32_16x16x32_bf16 v[56:59], v[236:239], v[192:195], 0
    ds_read_b64_tr_b16 v[232:233], v243 offset:320
    ds_read_b64_tr_b16 v[234:235], v243 offset:832
    v_max_f32 v252, v252, v215
    v_mfma_f32_16x16x32_bf16 v[60:63], v[236:239], v[200:203], 0
    v_max3_f32 v253, v216, v217, v218
    s_waitcnt lgkmcnt(4)
    v_mfma_f32_16x16x32_bf16 v[64:67], v[224:227], v[192:195], 0
    ds_read_b64_tr_b16 v[236:237], v243 offset:328
    ds_read_b64_tr_b16 v[238:239], v243 offset:840
    v_max3_f32 v253, v253, v219, v220
    v_mfma_f32_16x16x32_bf16 v[68:71], v[224:227], v[200:203], 0
    s_add_u32 m0, s55, 32
    s_nop 0
    buffer_load_dwordx4 v246, s[12:15], s45 offen offset:1024 nt lds
    s_add_u32 s45, s45, 16384
    s_and_b32 s45, s45, 0x3ffff
    s_waitcnt lgkmcnt(4)
    v_mfma_f32_16x16x32_bf16 v[72:75], v[228:231], v[192:195], 0
    ds_read_b64_tr_b16 v[224:225], v243 offset:384
    ds_read_b64_tr_b16 v[226:227], v243 offset:896
    v_max3_f32 v253, v253, v221, v222
    v_mfma_f32_16x16x32_bf16 v[76:79], v[228:231], v[200:203], 0
    v_max_f32 v253, v253, v223
    s_waitcnt lgkmcnt(4)
    v_mfma_f32_16x16x32_bf16 v[80:83], v[232:235], v[192:195], 0
    ds_read_b64_tr_b16 v[228:229], v243 offset:392
    ds_read_b64_tr_b16 v[230:231], v243 offset:904
    v_fma_f32 v254, v252, s42, v248
    v_mfma_f32_16x16x32_bf16 v[84:87], v[232:235], v[200:203], 0
    s_waitcnt lgkmcnt(4)
    v_mfma_f32_16x16x32_bf16 v[88:91], v[236:239], v[192:195], 0
    ds_read_b64_tr_b16 v[232:233], v243 offset:448
    ds_read_b64_tr_b16 v[234:235], v243 offset:960
    s_add_u32 m0, s78, 0
    s_nop 0
    buffer_load_dwordx4 v245, s[16:19], s46 offen nt lds
    v_cmp_lt_f32 s[92:93], s44, v254
    v_mfma_f32_16x16x32_bf16 v[92:95], v[236:239], v[200:203], 0
    v_fma_f32 v254, v253, s42, v249
    s_waitcnt lgkmcnt(4)
    v_mfma_f32_16x16x32_bf16 v[96:99], v[224:227], v[192:195], 0
    ds_read_b64_tr_b16 v[236:237], v243 offset:456
    ds_read_b64_tr_b16 v[238:239], v243 offset:968
    v_cmp_lt_f32 vcc, s44, v254
    v_mfma_f32_16x16x32_bf16 v[100:103], v[224:227], v[200:203], 0
    s_waitcnt lgkmcnt(4)
    v_mfma_f32_16x16x32_bf16 v[104:107], v[228:231], v[192:195], 0
    s_add_u32 s35, s35, 34816
    s_cmp_ge_u32 s35, 139264
    s_cselect_b32 s40, 139264, 0
    s_sub_u32 s35, s35, s40
    v_add_u32 v242, s35, v240
    v_xor_b32 v244, 16, v242
    v_add_u32 v243, s35, v241
    ds_read_b128 v[224:227], v242 offset:0
    v_mfma_f32_16x16x32_bf16 v[108:111], v[228:231], v[200:203], 0
    s_add_u32 m0, s78, 64
    s_nop 0
    buffer_load_dwordx4 v245, s[16:19], s46 offen offset:1024 nt lds
    s_add_u32 s46, s46, 16384
    s_and_b32 s46, s46, 0x3ffff
    s_waitcnt lgkmcnt(3)
    v_mfma_f32_16x16x32_bf16 v[112:115], v[232:235], v[192:195], 0
    ds_read_b128 v[228:231], v244 offset:512
    v_mfma_f32_16x16x32_bf16 v[116:119], v[232:235], v[200:203], 0
    s_waitcnt lgkmcnt(2)
    v_mfma_f32_16x16x32_bf16 v[120:123], v[236:239], v[192:195], 0
    ds_read_b128 v[232:235], v242 offset:64
    v_mfma_f32_16x16x32_bf16 v[124:127], v[236:239], v[200:203], 0
    s_or_b64 vcc, vcc, s[92:93]
    s_cbranch_scc1 L_rare_z
L_back_z:
    s_waitcnt lgkmcnt(2)
    v_mfma_f32_16x16x32_bf16 v[192:195], v[224:227], v[128:131], 0
    ds_read_b128 v[236:239], v244 offset:576
    v_fma_f32 v208, v208, s42, v248
    v_fma_f32 v209, v209, s42, v248
    v_mfma_f32_16x16x32_bf16 v[200:203], v[224:227], v[160:163], 0
    v_exp_f32 v208, v208
    v_exp_f32 v209, v209
    s_waitcnt lgkmcnt(2)
    v_mfma_f32_16x16x32_bf16 v[196:199], v[228:231], v[128:131], 0
    ds_read_b128 v[224:227], v242 offset:128
    v_add_f32 v250, v250, v208
    v_add_f32 v250, v250, v209
    v_mfma_f32_16x16x32_bf16 v[204:207], v[228:231], v[160:163], 0
    v_cvt_pk_bf16_f32 v208, v208, v209
    v_fma_f32 v210, v210, s42, v248
    s_waitcnt lgkmcnt(2)
    v_mfma_f32_16x16x32_bf16 v[192:195], v[232:235], v[132:135], v[192:195]
    ds_read_b128 v[228:231], v244 offset:640
    v_fma_f32 v211, v211, s42, v248
    v_exp_f32 v210, v210
    v_mfma_f32_16x16x32_bf16 v[200:203], v[232:235], v[164:167], v[200:203]
    v_exp_f32 v211, v211
    s_waitcnt lgkmcnt(2)
    v_mfma_f32_16x16x32_bf16 v[196:199], v[236:239], v[132:135], v[196:199]
    ds_read_b128 v[232:235], v242 offset:192
    v_add_f32 v250, v250, v210
    v_add_f32 v250, v250, v211
    v_mfma_f32_16x16x32_bf16 v[204:207], v[236:239], v[164:167], v[204:207]
    v_cvt_pk_bf16_f32 v209, v210, v211
    v_fma_f32 v212, v212, s42, v248
    s_waitcnt lgkmcnt(2)
    v_mfma_f32_16x16x32_bf16 v[192:195], v[224:227], v[136:139], v[192:195]
    ds_read_b128 v[236:239], v244 offset:704
    v_fma_f32 v213, v213, s42, v248
    v_exp_f32 v212, v212
    v_mfma_f32_16x16x32_bf16 v[200:203], v[224:227], v[168:171], v[200:203]
    v_exp_f32 v213, v213
    v_add_f32 v250, v250, v212
    s_waitcnt lgkmcnt(2)
    v_mfma_f32_16x16x32_bf16 v[196:199], v[228:231], v[136:139], v[196:199]
    ds_read_b128 v[224:227], v242 offset:256
    v_add_f32 v250, v250, v213
    v_mfma_f32_16x16x32_bf16 v[204:207], v[228:231], v[168:171], v[204:207]
    v_cvt_pk_bf16_f32 v210, v212, v213
    v_fma_f32 v214, v214, s42, v248
    s_waitcnt lgkmcnt(2)
    v_mfma_f32_16x16x32_bf16 v[192:195], v[232:235], v[140:143], v[192:195]
    ds_read_b128 v[228:231], v244 offset:768
    v_fma_f32 v215, v215, s42, v248
    v_exp_f32 v214, v214
    v_mfma_f32_16x16x32_bf16 v[200:203], v[232:235], v[172:175], v[200:203]
    v_exp_f32 v215, v215
    v_add_f32 v250, v250, v214
    s_waitcnt lgkmcnt(2)
    v_mfma_f32_16x16x32_bf16 v[196:199], v[236:239], v[140:143], v[196:199]
    ds_read_b128 v[232:235], v242 offset:320
    v_add_f32 v250, v250, v215
    v_cvt_pk_bf16_f32 v211, v214, v215
    v_mfma_f32_16x16x32_bf16 v[204:207], v[236:239], v[172:175], v[204:207]
    v_fma_f32 v216, v216, s42, v249
    s_waitcnt lgkmcnt(2)
    v_mfma_f32_16x16x32_bf16 v[192:195], v[224:227], v[144:147], v[192:195]
    ds_read_b128 v[236:239], v244 offset:832
    v_fma_f32 v217, v217, s42, v249
    v_exp_f32 v216, v216
    v_mfma_f32_16x16x32_bf16 v[200:203], v[224:227], v[176:179], v[200:203]
    v_exp_f32 v217, v217
    v_add_f32 v251, v251, v216
    s_waitcnt lgkmcnt(2)
    v_mfma_f32_16x16x32_bf16 v[196:199], v[228:231], v[144:147], v[196:199]
    ds_read_b128 v[224:227], v242 offset:384
    v_add_f32 v251, v251, v217
    v_cvt_pk_bf16_f32 v216, v216, v217
    v_mfma_f32_16x16x32_bf16 v[204:207], v[228:231], v[176:179], v[204:207]
    v_fma_f32 v218, v218, s42, v249
    v_fma_f32 v219, v219, s42, v249
    s_waitcnt lgkmcnt(2)
    v_mfma_f32_16x16x32_bf16 v[192:195], v[232:235], v[148:151], v[192:195]
    ds_read_b128 v[228:231], v244 offset:896
    v_exp_f32 v218, v218
    v_mfma_f32_16x16x32_bf16 v[200:203], v[232:235], v[180:183], v[200:203]
    v_exp_f32 v219, v219
    v_add_f32 v251, v251, v218
    s_waitcnt lgkmcnt(2)
    v_mfma_f32_16x16x32_bf16 v[196:199], v[236:239], v[148:151], v[196:199]
    ds_read_b128 v[232:235], v242 offset:448
    v_add_f32 v251, v251, v219
    v_cvt_pk_bf16_f32 v217, v218, v219
    v_mfma_f32_16x16x32_bf16 v[204:207], v[236:239], v[180:183], v[204:207]
    v_fma_f32 v220, v220, s42, v249
    v_fma_f32 v221, v221, s42, v249
    s_waitcnt lgkmcnt(2)
    v_mfma_f32_16x16x32_bf16 v[192:195], v[224:227], v[152:155], v[192:195]
    ds_read_b128 v[236:239], v244 offset:960
    v_exp_f32 v220, v220
    v_exp_f32 v221, v221
    v_mfma_f32_16x16x32_bf16 v[200:203], v[224:227], v[184:187], v[200:203]
    v_add_f32 v251, v251, v220
    s_waitcnt lgkmcnt(2)
    v_mfma_f32_16x16x32_bf16 v[196:199], v[228:231], v[152:155], v[196:199]
    ds_read_b64_tr_b16 v[224:225], v243 offset:0
    ds_read_b64_tr_b16 v[226:227], v243 offset:512
    v_add_f32 v251, v251, v221
    v_cvt_pk_bf16_f32 v218, v220, v221
    v_mfma_f32_16x16x32_bf16 v[204:207], v[228:231], v[184:187], v[204:207]
    v_fma_f32 v222, v222, s42, v249
    v_fma_f32 v223, v223, s42, v249
    s_waitcnt lgkmcnt(3)
    v_mfma_f32_16x16x32_bf16 v[192:195], v[232:235], v[156:159], v[192:195]
    ds_read_b64_tr_b16 v[228:229], v243 offset:8
    ds_read_b64_tr_b16 v[230:231], v243 offset:520
    v_exp_f32 v222, v222
    v_exp_f32 v223, v223
    v_mfma_f32_16x16x32_bf16 v[200:203], v[232:235], v[188:191], v[200:203]
    v_add_f32 v251, v251, v222
    v_add_f32 v251, v251, v223
    s_waitcnt lgkmcnt(4)
    v_mfma_f32_16x16x32_bf16 v[196:199], v[236:239], v[156:159], v[196:199]
    ds_read_b64_tr_b16 v[232:233], v243 offset:64
    ds_read_b64_tr_b16 v[234:235], v243 offset:576
    v_cvt_pk_bf16_f32 v219, v222, v223
    v_mfma_f32_16x16x32_bf16 v[204:207], v[236:239], v[188:191], v[204:207]
    s_waitcnt lgkmcnt(4)
    v_mfma_f32_16x16x32_bf16 v[0:3], v[224:227], v[208:211], v[0:3]
    ds_read_b64_tr_b16 v[236:237], v243 offset:72
    ds_read_b64_tr_b16 v[238:239], v243 offset:584
    v_mfma_f32_16x16x32_bf16 v[4:7], v[224:227], v[216:219], v[4:7]
    s_waitcnt lgkmcnt(4)
    v_mfma_f32_16x16x32_bf16 v[8:11], v[228:231], v[208:211], v[8:11]
    ds_read_b64_tr_b16 v[224:225], v243 offset:128
    ds_read_b64_tr_b16 v[226:227], v243 offset:640
    v_mfma_f32_16x16x32_bf16 v[12:15], v[228:231], v[216:219], v[12:15]
    s_waitcnt lgkmcnt(4)
    v_mfma_f32_16x16x32_bf16 v[16:19], v[232:235], v[208:211], v[16:19]
    ds_read_b64_tr_b16 v[228:229], v243 offset:136
    ds_read_b64_tr_b16 v[230:231], v243 offset:648
    v_mfma_f32_16x16x32_bf16 v[20:23], v[232:235], v[216:219], v[20:23]
    s_waitcnt lgkmcnt(4)
    v_mfma_f32_16x16x32_bf16 v[24:27], v[236:239], v[208:211], v[24:27]
    ds_read_b64_tr_b16 v[232:233], v243 offset:192
    ds_read_b64_tr_b16 v[234:235], v243 offset:704
    v_mfma_f32_16x16x32_bf16 v[28:31], v[236:239], v[216:219], v[28:31]
    s_waitcnt vmcnt(4)
    s_barrier
    s_add_u32 s55, s36, s48
    s_add_u32 s78, s36, s49
    s_add_u32 s36, s36, 34816
    s_cmp_ge_u32 s36, 139264
    s_cselect_b32 s40, 139264, 0
    s_sub_u32 s36, s36, s40
    s_waitcnt lgkmcnt(4)
    v_mfma_f32_16x16x32_bf16 v[32:35], v[224:227], v[208:211], v[32:35]
    ds_read_b64_tr_b16 v[236:237], v243 offset:200
    ds_read_b64_tr_b16 v[238:239], v243 offset:712
    v_mfma_f32_16x16x32_bf16 v[36:39], v[224:227], v[216:219], v[36:39]
    s_waitcnt lgkmcnt(4)
    v_mfma_f32_16x16x32_bf16 v[40:43], v[228:231], v[208:211], v[40:43]
    ds_read_b64_tr_b16 v[224:225], v243 offset:256
    ds_read_b64_tr_b16 v[226:227], v243 offset:768
    v_max3_f32 v252, v192, v193, v194
    v_mfma_f32_16x16x32_bf16 v[44:47], v[228:231], v[216:219], v[44:47]
    v_max3_f32 v252, v252, v195, v196
    s_waitcnt lgkmcnt(4)
    v_mfma_f32_16x16x32_bf16 v[48:51], v[232:235], v[208:211], v[48:51]
    ds_read_b64_tr_b16 v[228:229], v243 offset:264
    ds_read_b64_tr_b16 v[230:231], v243 offset:776
    s_add_u32 m0, s55, 0
    s_nop 0
    buffer_load_dwordx4 v246, s[12:15], s45 offen nt lds
    v_max3_f32 v252, v252, v197, v198
    v_mfma_f32_16x16x32_bf16 v[52:55], v[232:235], v[216:219], v[52:55]
    s_waitcnt lgkmcnt(4)
    v_mfma_f32_16x16x32_bf16 v[56:59], v[236:239], v[208:211], v[56:59]
    ds_read_b64_tr_b16 v[232:233], v243 offset:320
    ds_read_b64_tr_b16 v[234:235], v243 offset:832
    v_max_f32 v252, v252, v199
    v_mfma_f32_16x16x32_bf16 v[60:63], v[236:239], v[216:219], v[60:63]
    v_max3_f32 v253, v200, v201, v202
    s_waitcnt lgkmcnt(4)
    v_mfma_f32_16x16x32_bf16 v[64:67], v[224:227], v[208:211], v[64:67]
    ds_read_b64_tr_b16 v[236:237], v243 offset:328
    ds_read_b64_tr_b16 v[238:239], v243 offset:840
    v_max3_f32 v253, v253, v203, v204
    v_mfma_f32_16x16x32_bf16 v[68:71], v[224:227], v[216:219], v[68:71]
    s_add_u32 m0, s55, 32
    s_nop 0
    buffer_load_dwordx4 v246, s[12:15], s45 offen offset:1024 nt lds
    s_add_u32 s45, s45, 16384
    s_and_b32 s45, s45, 0x3ffff
    s_waitcnt lgkmcnt(4)
    v_mfma_f32_16x16x32_bf16 v[72:75], v[228:231], v[208:211], v[72:75]
    ds_read_b64_tr_b16 v[224:225], v243 offset:384
    ds_read_b64_tr_b16 v[226:227], v243 offset:896
    v_max3_f32 v253, v253, v205, v206
    v_mfma_f32_16x16x32_bf16 v[76:79], v[228:231], v[216:219], v[76:79]
    v_max_f32 v253, v253, v207
    s_waitcnt lgkmcnt(4)
    v_mfma_f32_16x16x32_bf16 v[80:83], v[232:235], v[208:211], v[80:83]
    ds_read_b64_tr_b16 v[228:229], v243 offset:392
    ds_read_b64_tr_b16 v[230:231], v243 offset:904
    v_fma_f32 v254, v252, s42, v248
    v_mfma_f32_16x16x32_bf16 v[84:87], v[232:235], v[216:219], v[84:87]
    s_waitcnt lgkmcnt(4)
    v_mfma_f32_16x16x32_bf16 v[88:91], v[236:239], v[208:211], v[88:91]
    ds_read_b64_tr_b16 v[232:233], v243 offset:448
    ds_read_b64_tr_b16 v[234:235], v243 offset:960
    s_add_u32 m0, s78, 0
    s_nop 0
    buffer_load_dwordx4 v245, s[16:19], s46 offen nt lds
    v_cmp_lt_f32 s[92:93], s44, v254
    v_mfma_f32_16x16x32_bf16 v[92:95], v[236:239], v[216:219], v[92:95]
    v_fma_f32 v254, v253, s42, v249
    s_waitcnt lgkmcnt(4)
    v_mfma_f32_16x16x32_bf16 v[96:99], v[224:227], v[208:211], v[96:99]
    ds_read_b64_tr_b16 v[236:237], v243 offset:456
    ds_read_b64_tr_b16 v[238:239], v243 offset:968
    v_cmp_lt_f32 vcc, s44, v254
    v_mfma_f32_16x16x32_bf16 v[100:103], v[224:227], v[216:219], v[100:103]
    s_waitcnt lgkmcnt(4)
    v_mfma_f32_16x16x32_bf16 v[104:107], v[228:231], v[208:211], v[104:107]
    s_add_u32 s35, s35, 34816
    s_cmp_ge_u32 s35, 139264
    s_cselect_b32 s40, 139264, 0
    s_sub_u32 s35, s35, s40
    v_add_u32 v242, s35, v240
    v_xor_b32 v244, 16, v242
    v_add_u32 v243, s35, v241
    ds_read_b128 v[224:227], v242 offset:0
    v_mfma_f32_16x16x32_bf16 v[108:111], v[228:231], v[216:219], v[108:111]
    s_add_u32 m0, s78, 64
    s_nop 0
    buffer_load_dwordx4 v245, s[16:19], s46 offen offset:1024 nt lds
    s_add_u32 s46, s46, 16384
    s_and_b32 s46, s46, 0x3ffff
    s_waitcnt lgkmcnt(3)
    v_mfma_f32_16x16x32_bf16 v[112:115], v[232:235], v[208:211], v[112:115]
    ds_read_b128 v[228:231], v244 offset:512
    v_mfma_f32_16x16x32_bf16 v[116:119], v[232:235], v[216:219], v[116:119]
    s_waitcnt lgkmcnt(2)
    v_mfma_f32_16x16x32_bf16 v[120:123], v[236:239], v[208:211], v[120:123]
    ds_read_b128 v[232:235], v242 offset:64
    v_mfma_f32_16x16x32_bf16 v[124:127], v[236:239], v[216:219], v[124:127]
    s_or_b64 vcc, vcc, s[92:93]
    s_cbranch_scc1 L_rare_y
L_back_y:
    s_mov_b32 s41, 5
L_p2:
    s_waitcnt lgkmcnt(2)
    v_mfma_f32_16x16x32_bf16 v[208:211], v[224:227], v[128:131], 0
    ds_read_b128 v[236:239], v244 offset:576
    v_fma_f32 v192, v192, s42, v248
    v_fma_f32 v193, v193, s42, v248
    v_mfma_f32_16x16x32_bf16 v[216:219], v[224:227], v[160:163], 0
    v_exp_f32 v192, v192
    v_exp_f32 v193, v193
    s_waitcnt lgkmcnt(2)
    v_mfma_f32_16x16x32_bf16 v[212:215], v[228:231], v[128:131], 0
    ds_read_b128 v[224:227], v242 offset:128
    v_add_f32 v250, v250, v192
    v_add_f32 v250, v250, v193
    v_mfma_f32_16x16x32_bf16 v[220:223], v[228:231], v[160:163], 0
    v_cvt_pk_bf16_f32 v192, v192, v193
    v_fma_f32 v194, v194, s42, v248
    s_waitcnt lgkmcnt(2)
    v_mfma_f32_16x16x32_bf16 v[208:211], v[232:235], v[132:135], v[208:211]
    ds_read_b128 v[228:231], v244 offset:640
    v_fma_f32 v195, v195, s42, v248
    v_exp_f32 v194, v194
    v_mfma_f32_16x16x32_bf16 v[216:219], v[232:235], v[164:167], v[216:219]
    v_exp_f32 v195, v195
    s_waitcnt lgkmcnt(2)
    v_mfma_f32_16x16x32_bf16 v[212:215], v[236:239], v[132:135], v[212:215]
    ds_read_b128 v[232:235], v242 offset:192
    v_add_f32 v250, v250, v194
    v_add_f32 v250, v250, v195
    v_mfma_f32_16x16x32_bf16 v[220:223], v[236:239], v[164:167], v[220:223]
    v_cvt_pk_bf16_f32 v193, v194, v195
    v_fma_f32 v196, v196, s42, v248
    s_waitcnt lgkmcnt(2)
    v_mfma_f32_16x16x32_bf16 v[208:211], v[224:227], v[136:139], v[208:211]
    ds_read_b128 v[236:239], v244 offset:704
    v_fma_f32 v197, v197, s42, v248
    v_exp_f32 v196, v196
    v_mfma_f32_16x16x32_bf16 v[216:219], v[224:227], v[168:171], v[216:219]
    v_exp_f32 v197, v197
    v_add_f32 v250, v250, v196
    s_waitcnt lgkmcnt(2)
    v_mfma_f32_16x16x32_bf16 v[212:215], v[228:231], v[136:139], v[212:215]
    ds_read_b128 v[224:227], v242 offset:256
    v_add_f32 v250, v250, v197
    v_mfma_f32_16x16x32_bf16 v[220:223], v[228:231], v[168:171], v[220:223]
    v_cvt_pk_bf16_f32 v194, v196, v197
    v_fma_f32 v198, v198, s42, v248
    s_waitcnt lgkmcnt(2)
    v_mfma_f32_16x16x32_bf16 v[208:211], v[232:235], v[140:143], v[208:211]
    ds_read_b128 v[228:231], v244 offset:768
    v_fma_f32 v199, v199, s42, v248
    v_exp_f32 v198, v198
    v_mfma_f32_16x16x32_bf16 v[216:219], v[232:235], v[172:175], v[216:219]
    v_exp_f32 v199, v199
    v_add_f32 v250, v250, v198
    s_waitcnt lgkmcnt(2)
    v_mfma_f32_16x16x32_bf16 v[212:215], v[236:239], v[140:143], v[212:215]
    ds_read_b128 v[232:235], v242 offset:320
    v_add_f32 v250, v250, v199
    v_cvt_pk_bf16_f32 v195, v198, v199
    v_mfma_f32_16x16x32_bf16 v[220:223], v[236:239], v[172:175], v[220:223]
    v_fma_f32 v200, v200, s42, v249
    s_waitcnt lgkmcnt(2)
    v_mfma_f32_16x16x32_bf16 v[208:211], v[224:227], v[144:147], v[208:211]
    ds_read_b128 v[236:239], v244 offset:832
    v_fma_f32 v201, v201, s42, v249
    v_exp_f32 v200, v200
    v_mfma_f32_16x16x32_bf16 v[216:219], v[224:227], v[176:179], v[216:219]
    v_exp_f32 v201, v201
    v_add_f32 v251, v251, v200
    s_waitcnt lgkmcnt(2)
    v_mfma_f32_16x16x32_bf16 v[212:215], v[228:231], v[144:147], v[212:215]
    ds_read_b128 v[224:227], v242 offset:384
    v_add_f32 v251, v251, v201
    v_cvt_pk_bf16_f32 v200, v200, v201
    v_mfma_f32_16x16x32_bf16 v[220:223], v[228:231], v[176:179], v[220:223]
    v_fma_f32 v202, v202, s42, v249
    v_fma_f32 v203, v203, s42, v249
    s_waitcnt lgkmcnt(2)
    v_mfma_f32_16x16x32_bf16 v[208:211], v[232:235], v[148:151], v[208:211]
    ds_read_b128 v[228:231], v244 offset:896
    v_exp_f32 v202, v202
    v_mfma_f32_16x16x32_bf16 v[216:219], v[232:235], v[180:183], v[216:219]
    v_exp_f32 v203, v203
    v_add_f32 v251, v251, v202
    s_waitcnt lgkmcnt(2)
    v_mfma_f32_16x16x32_bf16 v[212:215], v[236:239], v[148:151], v[212:215]
    ds_read_b128 v[232:235], v242 offset:448
    v_add_f32 v251, v251, v203
    v_cvt_pk_bf16_f32 v201, v202, v203
    v_mfma_f32_16x16x32_bf16 v[220:223], v[236:239], v[180:183], v[220:223]
    v_fma_f32 v204, v204, s42, v249
    v_fma_f32 v205, v205, s42, v249
    s_waitcnt lgkmcnt(2)
    v_mfma_f32_16x16x32_bf16 v[208:211], v[224:227], v[152:155], v[208:211]
    ds_read_b128 v[236:239], v244 offset:960
    v_exp_f32 v204, v204
    v_exp_f32 v205, v205
    v_mfma_f32_16x16x32_bf16 v[216:219], v[224:227], v[184:187], v[216:219]
    v_add_f32 v251, v251, v204
    s_waitcnt lgkmcnt(2)
    v_mfma_f32_16x16x32_bf16 v[212:215], v[228:231], v[152:155], v[212:215]
    ds_read_b64_tr_b16 v[224:225], v243 offset:0
    ds_read_b64_tr_b16 v[226:227], v243 offset:512
    v_add_f32 v251, v251, v205
    v_cvt_pk_bf16_f32 v202, v204, v205
    v_mfma_f32_16x16x32_bf16 v[220:223], v[228:231], v[184:187], v[220:223]
    v_fma_f32 v206, v206, s42, v249
    v_fma_f32 v207, v207, s42, v249
    s_waitcnt lgkmcnt(3)
    v_mfma_f32_16x16x32_bf16 v[208:211], v[232:235], v[156:159], v[208:211]
    ds_read_b64_tr_b16 v[228:229], v243 offset:8
    ds_read_b64_tr_b16 v[230:231], v243 offset:520
    v_exp_f32 v206, v206
    v_exp_f32 v207, v207
    v_mfma_f32_16x16x32_bf16 v[216:219], v[232:235], v[188:191], v[216:219]
    v_add_f32 v251, v251, v206
    v_add_f32 v251, v251, v207
    s_waitcnt lgkmcnt(4)
    v_mfma_f32_16x16x32_bf16 v[212:215], v[236:239], v[156:159], v[212:215]
    ds_read_b64_tr_b16 v[232:233], v243 offset:64
    ds_read_b64_tr_b16 v[234:235], v243 offset:576
    v_cvt_pk_bf16_f32 v203, v206, v207
    v_mfma_f32_16x16x32_bf16 v[220:223], v[236:239], v[188:191], v[220:223]
    s_waitcnt lgkmcnt(4)
    v_mfma_f32_16x16x32_bf16 v[0:3], v[224:227], v[192:195], v[0:3]
    ds_read_b64_tr_b16 v[236:237], v243 offset:72
    ds_read_b64_tr_b16 v[238:239], v243 offset:584
    v_mfma_f32_16x16x32_bf16 v[4:7], v[224:227], v[200:203], v[4:7]
    s_waitcnt lgkmcnt(4)
    v_mfma_f32_16x16x32_bf16 v[8:11], v[228:231], v[192:195], v[8:11]
    ds_read_b64_tr_b16 v[224:225], v243 offset:128
    ds_read_b64_tr_b16 v[226:227], v243 offset:640
    v_mfma_f32_16x16x32_bf16 v[12:15], v[228:231], v[200:203], v[12:15]
    s_waitcnt lgkmcnt(4)
    v_mfma_f32_16x16x32_bf16 v[16:19], v[232:235], v[192:195], v[16:19]
    ds_read_b64_tr_b16 v[228:229], v243 offset:136
    ds_read_b64_tr_b16 v[230:231], v243 offset:648
    v_mfma_f32_16x16x32_bf16 v[20:23], v[232:235], v[200:203], v[20:23]
    s_waitcnt lgkmcnt(4)
    v_mfma_f32_16x16x32_bf16 v[24:27], v[236:239], v[192:195], v[24:27]
    ds_read_b64_tr_b16 v[232:233], v243 offset:192
    ds_read_b64_tr_b16 v[234:235], v243 offset:704
    v_mfma_f32_16x16x32_bf16 v[28:31], v[236:239], v[200:203], v[28:31]
    s_waitcnt vmcnt(4)
    s_barrier
    s_add_u32 s55, s36, s48
    s_add_u32 s78, s36, s49
    s_add_u32 s36, s36, 34816
    s_cmp_ge_u32 s36, 139264
    s_cselect_b32 s40, 139264, 0
    s_sub_u32 s36, s36, s40
    s_waitcnt lgkmcnt(4)
    v_mfma_f32_16x16x32_bf16 v[32:35], v[224:227], v[192:195], v[32:35]
    ds_read_b64_tr_b16 v[236:237], v243 offset:200
    ds_read_b64_tr_b16 v[238:239], v243 offset:712
    v_mfma_f32_16x16x32_bf16 v[36:39], v[224:227], v[200:203], v[36:39]
    s_waitcnt lgkmcnt(4)
    v_mfma_f32_16x16x32_bf16 v[40:43], v[228:231], v[192:195], v[40:43]
    ds_read_b64_tr_b16 v[224:225], v243 offset:256
    ds_read_b64_tr_b16 v[226:227], v243 offset:768
    v_max3_f32 v252, v208, v209, v210
    v_mfma_f32_16x16x32_bf16 v[44:47], v[228:231], v[200:203], v[44:47]
    v_max3_f32 v252, v252, v211, v212
    s_waitcnt lgkmcnt(4)
    v_mfma_f32_16x16x32_bf16 v[48:51], v[232:235], v[192:195], v[48:51]
    ds_read_b64_tr_b16 v[228:229], v243 offset:264
    ds_read_b64_tr_b16 v[230:231], v243 offset:776
    s_add_u32 m0, s55, 0
    s_nop 0
    buffer_load_dwordx4 v246, s[12:15], s45 offen nt lds
    v_max3_f32 v252, v252, v213, v214
    v_mfma_f32_16x16x32_bf16 v[52:55], v[232:235], v[200:203], v[52:55]
    s_waitcnt lgkmcnt(4)
    v_mfma_f32_16x16x32_bf16 v[56:59], v[236:239], v[192:195], v[56:59]
    ds_read_b64_tr_b16 v[232:233], v243 offset:320
    ds_read_b64_tr_b16 v[234:235], v243 offset:832
    v_max_f32 v252, v252, v215
    v_mfma_f32_16x16x32_bf16 v[60:63], v[236:239], v[200:203], v[60:63]
    v_max3_f32 v253, v216, v217, v218
    s_waitcnt lgkmcnt(4)
    v_mfma_f32_16x16x32_bf16 v[64:67], v[224:227], v[192:195], v[64:67]
    ds_read_b64_tr_b16 v[236:237], v243 offset:328
    ds_read_b64_tr_b16 v[238:239], v243 offset:840
    v_max3_f32 v253, v253, v219, v220
    v_mfma_f32_16x16x32_bf16 v[68:71], v[224:227], v[200:203], v[68:71]
    s_add_u32 m0, s55, 32
    s_nop 0
    buffer_load_dwordx4 v246, s[12:15], s45 offen offset:1024 nt lds
    s_add_u32 s45, s45, 16384
    s_and_b32 s45, s45, 0x3ffff
    s_waitcnt lgkmcnt(4)
    v_mfma_f32_16x16x32_bf16 v[72:75], v[228:231], v[192:195], v[72:75]
    ds_read_b64_tr_b16 v[224:225], v243 offset:384
    ds_read_b64_tr_b16 v[226:227], v243 offset:896
    v_max3_f32 v253, v253, v221, v222
    v_mfma_f32_16x16x32_bf16 v[76:79], v[228:231], v[200:203], v[76:79]
    v_max_f32 v253, v253, v223
    s_waitcnt lgkmcnt(4)
    v_mfma_f32_16x16x32_bf16 v[80:83], v[232:235], v[192:195], v[80:83]
    ds_read_b64_tr_b16 v[228:229], v243 offset:392
    ds_read_b64_tr_b16 v[230:231], v243 offset:904
    v_fma_f32 v254, v252, s42, v248
    v_mfma_f32_16x16x32_bf16 v[84:87], v[232:235], v[200:203], v[84:87]
    s_waitcnt lgkmcnt(4)
    v_mfma_f32_16x16x32_bf16 v[88:91], v[236:239], v[192:195], v[88:91]
    ds_read_b64_tr_b16 v[232:233], v243 offset:448
    ds_read_b64_tr_b16 v[234:235], v243 offset:960
    s_add_u32 m0, s78, 0
    s_nop 0
    buffer_load_dwordx4 v245, s[16:19], s46 offen nt lds
    v_cmp_lt_f32 s[92:93], s44, v254
    v_mfma_f32_16x16x32_bf16 v[92:95], v[236:239], v[200:203], v[92:95]
    v_fma_f32 v254, v253, s42, v249
    s_waitcnt lgkmcnt(4)
    v_mfma_f32_16x16x32_bf16 v[96:99], v[224:227], v[192:195], v[96:99]
    ds_read_b64_tr_b16 v[236:237], v243 offset:456
    ds_read_b64_tr_b16 v[238:239], v243 offset:968
    v_cmp_lt_f32 vcc, s44, v254
    v_mfma_f32_16x16x32_bf16 v[100:103], v[224:227], v[200:203], v[100:103]
    s_waitcnt lgkmcnt(4)
    v_mfma_f32_16x16x32_bf16 v[104:107], v[228:231], v[192:195], v[104:107]
    s_add_u32 s35, s35, 34816
    s_cmp_ge_u32 s35, 139264
    s_cselect_b32 s40, 139264, 0
    s_sub_u32 s35, s35, s40
    v_add_u32 v242, s35, v240
    v_xor_b32 v244, 16, v242
    v_add_u32 v243, s35, v241
    ds_read_b128 v[224:227], v242 offset:0
    v_mfma_f32_16x16x32_bf16 v[108:111], v[228:231], v[200:203], v[108:111]
    s_add_u32 m0, s78, 64
    s_nop 0
    buffer_load_dwordx4 v245, s[16:19], s46 offen offset:1024 nt lds
    s_add_u32 s46, s46, 16384
    s_and_b32 s46, s46, 0x3ffff
    s_waitcnt lgkmcnt(3)
    v_mfma_f32_16x16x32_bf16 v[112:115], v[232:235], v[192:195], v[112:115]
    ds_read_b128 v[228:231], v244 offset:512
    v_mfma_f32_16x16x32_bf16 v[116:119], v[232:235], v[200:203], v[116:119]
    s_waitcnt lgkmcnt(2)
    v_mfma_f32_16x16x32_bf16 v[120:123], v[236:239], v[192:195], v[120:123]
    ds_read_b128 v[232:235], v242 offset:64
    v_mfma_f32_16x16x32_bf16 v[124:127], v[236:239], v[200:203], v[124:127]
    s_or_b64 vcc, vcc, s[92:93]
    s_cbranch_scc1 L_rare_a
L_back_a:
    s_waitcnt lgkmcnt(2)
    v_mfma_f32_16x16x32_bf16 v[192:195], v[224:227], v[128:131], 0
    ds_read_b128 v[236:239], v244 offset:576
    v_fma_f32 v208, v208, s42, v248
    v_fma_f32 v209, v209, s42, v248
    v_mfma_f32_16x16x32_bf16 v[200:203], v[224:227], v[160:163], 0
    v_exp_f32 v208, v208
    v_exp_f32 v209, v209
    s_waitcnt lgkmcnt(2)
    v_mfma_f32_16x16x32_bf16 v[196:199], v[228:231], v[128:131], 0
    ds_read_b128 v[224:227], v242 offset:128
    v_add_f32 v250, v250, v208
    v_add_f32 v250, v250, v209
    v_mfma_f32_16x16x32_bf16 v[204:207], v[228:231], v[160:163], 0
    v_cvt_pk_bf16_f32 v208, v208, v209
    v_fma_f32 v210, v210, s42, v248
    s_waitcnt lgkmcnt(2)
    v_mfma_f32_16x16x32_bf16 v[192:195], v[232:235], v[132:135], v[192:195]
    ds_read_b128 v[228:231], v244 offset:640
    v_fma_f32 v211, v211, s42, v248
    v_exp_f32 v210, v210
    v_mfma_f32_16x16x32_bf16 v[200:203], v[232:235], v[164:167], v[200:203]
    v_exp_f32 v211, v211
    s_waitcnt lgkmcnt(2)
    v_mfma_f32_16x16x32_bf16 v[196:199], v[236:239], v[132:135], v[196:199]
    ds_read_b128 v[232:235], v242 offset:192
    v_add_f32 v250, v250, v210
    v_add_f32 v250, v250, v211
    v_mfma_f32_16x16x32_bf16 v[204:207], v[236:239], v[164:167], v[204:207]
    v_cvt_pk_bf16_f32 v209, v210, v211
    v_fma_f32 v212, v212, s42, v248
    s_waitcnt lgkmcnt(2)
    v_mfma_f32_16x16x32_bf16 v[192:195], v[224:227], v[136:139], v[192:195]
    ds_read_b128 v[236:239], v244 offset:704
    v_fma_f32 v213, v213, s42, v248
    v_exp_f32 v212, v212
    v_mfma_f32_16x16x32_bf16 v[200:203], v[224:227], v[168:171], v[200:203]
    v_exp_f32 v213, v213
    v_add_f32 v250, v250, v212
    s_waitcnt lgkmcnt(2)
    v_mfma_f32_16x16x32_bf16 v[196:199], v[228:231], v[136:139], v[196:199]
    ds_read_b128 v[224:227], v242 offset:256
    v_add_f32 v250, v250, v213
    v_mfma_f32_16x16x32_bf16 v[204:207], v[228:231], v[168:171], v[204:207]
    v_cvt_pk_bf16_f32 v210, v212, v213
    v_fma_f32 v214, v214, s42, v248
    s_waitcnt lgkmcnt(2)
    v_mfma_f32_16x16x32_bf16 v[192:195], v[232:235], v[140:143], v[192:195]
    ds_read_b128 v[228:231], v244 offset:768
    v_fma_f32 v215, v215, s42, v248
    v_exp_f32 v214, v214
    v_mfma_f32_16x16x32_bf16 v[200:203], v[232:235], v[172:175], v[200:203]
    v_exp_f32 v215, v215
    v_add_f32 v250, v250, v214
    s_waitcnt lgkmcnt(2)
    v_mfma_f32_16x16x32_bf16 v[196:199], v[236:239], v[140:143], v[196:199]
    ds_read_b128 v[232:235], v242 offset:320
    v_add_f32 v250, v250, v215
    v_cvt_pk_bf16_f32 v211, v214, v215
    v_mfma_f32_16x16x32_bf16 v[204:207], v[236:239], v[172:175], v[204:207]
    v_fma_f32 v216, v216, s42, v249
    s_waitcnt lgkmcnt(2)
    v_mfma_f32_16x16x32_bf16 v[192:195], v[224:227], v[144:147], v[192:195]
    ds_read_b128 v[236:239], v244 offset:832
    v_fma_f32 v217, v217, s42, v249
    v_exp_f32 v216, v216
    v_mfma_f32_16x16x32_bf16 v[200:203], v[224:227], v[176:179], v[200:203]
    v_exp_f32 v217, v217
    v_add_f32 v251, v251, v216
    s_waitcnt lgkmcnt(2)
    v_mfma_f32_16x16x32_bf16 v[196:199], v[228:231], v[144:147], v[196:199]
    ds_read_b128 v[224:227], v242 offset:384
    v_add_f32 v251, v251, v217
    v_cvt_pk_bf16_f32 v216, v216, v217
    v_mfma_f32_16x16x32_bf16 v[204:207], v[228:231], v[176:179], v[204:207]
    v_fma_f32 v218, v218, s42, v249
    v_fma_f32 v219, v219, s42, v249
    s_waitcnt lgkmcnt(2)
    v_mfma_f32_16x16x32_bf16 v[192:195], v[232:235], v[148:151], v[192:195]
    ds_read_b128 v[228:231], v244 offset:896
    v_exp_f32 v218, v218
    v_mfma_f32_16x16x32_bf16 v[200:203], v[232:235], v[180:183], v[200:203]
    v_exp_f32 v219, v219
    v_add_f32 v251, v251, v218
    s_waitcnt lgkmcnt(2)
    v_mfma_f32_16x16x32_bf16 v[196:199], v[236:239], v[148:151], v[196:199]
    ds_read_b128 v[232:235], v242 offset:448
    v_add_f32 v251, v251, v219
    v_cvt_pk_bf16_f32 v217, v218, v219
    v_mfma_f32_16x16x32_bf16 v[204:207], v[236:239], v[180:183], v[204:207]
    v_fma_f32 v220, v220, s42, v249
    v_fma_f32 v221, v221, s42, v249
    s_waitcnt lgkmcnt(2)
    v_mfma_f32_16x16x32_bf16 v[192:195], v[224:227], v[152:155], v[192:195]
    ds_read_b128 v[236:239], v244 offset:960
    v_exp_f32 v220, v220
    v_exp_f32 v221, v221
    v_mfma_f32_16x16x32_bf16 v[200:203], v[224:227], v[184:187], v[200:203]
    v_add_f32 v251, v251, v220
    s_waitcnt lgkmcnt(2)
    v_mfma_f32_16x16x32_bf16 v[196:199], v[228:231], v[152:155], v[196:199]
    ds_read_b64_tr_b16 v[224:225], v243 offset:0
    ds_read_b64_tr_b16 v[226:227], v243 offset:512
    v_add_f32 v251, v251, v221
    v_cvt_pk_bf16_f32 v218, v220, v221
    v_mfma_f32_16x16x32_bf16 v[204:207], v[228:231], v[184:187], v[204:207]
    v_fma_f32 v222, v222, s42, v249
    v_fma_f32 v223, v223, s42, v249
    s_waitcnt lgkmcnt(3)
    v_mfma_f32_16x16x32_bf16 v[192:195], v[232:235], v[156:159], v[192:195]
    ds_read_b64_tr_b16 v[228:229], v243 offset:8
    ds_read_b64_tr_b16 v[230:231], v243 offset:520
    v_exp_f32 v222, v222
    v_exp_f32 v223, v223
    v_mfma_f32_16x16x32_bf16 v[200:203], v[232:235], v[188:191], v[200:203]
    v_add_f32 v251, v251, v222
    v_add_f32 v251, v251, v223
    s_waitcnt lgkmcnt(4)
    v_mfma_f32_16x16x32_bf16 v[196:199], v[236:239], v[156:159], v[196:199]
    ds_read_b64_tr_b16 v[232:233], v243 offset:64
    ds_read_b64_tr_b16 v[234:235], v243 offset:576
    v_cvt_pk_bf16_f32 v219, v222, v223
    v_mfma_f32_16x16x32_bf16 v[204:207], v[236:239], v[188:191], v[204:207]
    s_waitcnt lgkmcnt(4)
    v_mfma_f32_16x16x32_bf16 v[0:3], v[224:227], v[208:211], v[0:3]
    ds_read_b64_tr_b16 v[236:237], v243 offset:72
    ds_read_b64_tr_b16 v[238:239], v243 offset:584
    v_mfma_f32_16x16x32_bf16 v[4:7], v[224:227], v[216:219], v[4:7]
    s_waitcnt lgkmcnt(4)
    v_mfma_f32_16x16x32_bf16 v[8:11], v[228:231], v[208:211], v[8:11]
    ds_read_b64_tr_b16 v[224:225], v243 offset:128
    ds_read_b64_tr_b16 v[226:227], v243 offset:640
    v_mfma_f32_16x16x32_bf16 v[12:15], v[228:231], v[216:219], v[12:15]
    s_waitcnt lgkmcnt(4)
    v_mfma_f32_16x16x32_bf16 v[16:19], v[232:235], v[208:211], v[16:19]
    ds_read_b64_tr_b16 v[228:229], v243 offset:136
    ds_read_b64_tr_b16 v[230:231], v243 offset:648
    v_mfma_f32_16x16x32_bf16 v[20:23], v[232:235], v[216:219], v[20:23]
    s_waitcnt lgkmcnt(4)
    v_mfma_f32_16x16x32_bf16 v[24:27], v[236:239], v[208:211], v[24:27]
    ds_read_b64_tr_b16 v[232:233], v243 offset:192
    ds_read_b64_tr_b16 v[234:235], v243 offset:704
    v_mfma_f32_16x16x32_bf16 v[28:31], v[236:239], v[216:219], v[28:31]
    s_waitcnt vmcnt(4)
    s_barrier
    s_add_u32 s55, s36, s48
    s_add_u32 s78, s36, s49
    s_add_u32 s36, s36, 34816
    s_cmp_ge_u32 s36, 139264
    s_cselect_b32 s40, 139264, 0
    s_sub_u32 s36, s36, s40
    s_waitcnt lgkmcnt(4)
    v_mfma_f32_16x16x32_bf16 v[32:35], v[224:227], v[208:211], v[32:35]
    ds_read_b64_tr_b16 v[236:237], v243 offset:200
    ds_read_b64_tr_b16 v[238:239], v243 offset:712
    v_mfma_f32_16x16x32_bf16 v[36:39], v[224:227], v[216:219], v[36:39]
    s_waitcnt lgkmcnt(4)
    v_mfma_f32_16x16x32_bf16 v[40:43], v[228:231], v[208:211], v[40:43]
    ds_read_b64_tr_b16 v[224:225], v243 offset:256
    ds_read_b64_tr_b16 v[226:227], v243 offset:768
    v_max3_f32 v252, v192, v193, v194
    v_mfma_f32_16x16x32_bf16 v[44:47], v[228:231], v[216:219], v[44:47]
    v_max3_f32 v252, v252, v195, v196
    s_waitcnt lgkmcnt(4)
    v_mfma_f32_16x16x32_bf16 v[48:51], v[232:235], v[208:211], v[48:51]
    ds_read_b64_tr_b16 v[228:229], v243 offset:264
    ds_read_b64_tr_b16 v[230:231], v243 offset:776
    s_add_u32 m0, s55, 0
    s_nop 0
    buffer_load_dwordx4 v246, s[12:15], s45 offen nt lds
    v_max3_f32 v252, v252, v197, v198
    v_mfma_f32_16x16x32_bf16 v[52:55], v[232:235], v[216:219], v[52:55]
    s_waitcnt lgkmcnt(4)
    v_mfma_f32_16x16x32_bf16 v[56:59], v[236:239], v[208:211], v[56:59]
    ds_read_b64_tr_b16 v[232:233], v243 offset:320
    ds_read_b64_tr_b16 v[234:235], v243 offset:832
    v_max_f32 v252, v252, v199
    v_mfma_f32_16x16x32_bf16 v[60:63], v[236:239], v[216:219], v[60:63]
    v_max3_f32 v253, v200, v201, v202
    s_waitcnt lgkmcnt(4)
    v_mfma_f32_16x16x32_bf16 v[64:67], v[224:227], v[208:211], v[64:67]
    ds_read_b64_tr_b16 v[236:237], v243 offset:328
    ds_read_b64_tr_b16 v[238:239], v243 offset:840
    v_max3_f32 v253, v253, v203, v204
    v_mfma_f32_16x16x32_bf16 v[68:71], v[224:227], v[216:219], v[68:71]
    s_add_u32 m0, s55, 32
    s_nop 0
    buffer_load_dwordx4 v246, s[12:15], s45 offen offset:1024 nt lds
    s_add_u32 s45, s45, 16384
    s_and_b32 s45, s45, 0x3ffff
    s_waitcnt lgkmcnt(4)
    v_mfma_f32_16x16x32_bf16 v[72:75], v[228:231], v[208:211], v[72:75]
    ds_read_b64_tr_b16 v[224:225], v243 offset:384
    ds_read_b64_tr_b16 v[226:227], v243 offset:896
    v_max3_f32 v253, v253, v205, v206
    v_mfma_f32_16x16x32_bf16 v[76:79], v[228:231], v[216:219], v[76:79]
    v_max_f32 v253, v253, v207
    s_waitcnt lgkmcnt(4)
    v_mfma_f32_16x16x32_bf16 v[80:83], v[232:235], v[208:211], v[80:83]
    ds_read_b64_tr_b16 v[228:229], v243 offset:392
    ds_read_b64_tr_b16 v[230:231], v243 offset:904
    v_fma_f32 v254, v252, s42, v248
    v_mfma_f32_16x16x32_bf16 v[84:87], v[232:235], v[216:219], v[84:87]
    s_waitcnt lgkmcnt(4)
    v_mfma_f32_16x16x32_bf16 v[88:91], v[236:239], v[208:211], v[88:91]
    ds_read_b64_tr_b16 v[232:233], v243 offset:448
    ds_read_b64_tr_b16 v[234:235], v243 offset:960
    s_add_u32 m0, s78, 0
    s_nop 0
    buffer_load_dwordx4 v245, s[16:19], s46 offen nt lds
    v_cmp_lt_f32 s[92:93], s44, v254
    v_mfma_f32_16x16x32_bf16 v[92:95], v[236:239], v[216:219], v[92:95]
    v_fma_f32 v254, v253, s42, v249
    s_waitcnt lgkmcnt(4)
    v_mfma_f32_16x16x32_bf16 v[96:99], v[224:227], v[208:211], v[96:99]
    ds_read_b64_tr_b16 v[236:237], v243 offset:456
    ds_read_b64_tr_b16 v[238:239], v243 offset:968
    v_cmp_lt_f32 vcc, s44, v254
    v_mfma_f32_16x16x32_bf16 v[100:103], v[224:227], v[216:219], v[100:103]
    s_waitcnt lgkmcnt(4)
    v_mfma_f32_16x16x32_bf16 v[104:107], v[228:231], v[208:211], v[104:107]
    s_add_u32 s35, s35, 34816
    s_cmp_ge_u32 s35, 139264
    s_cselect_b32 s40, 139264, 0
    s_sub_u32 s35, s35, s40
    v_add_u32 v242, s35, v240
    v_xor_b32 v244, 16, v242
    v_add_u32 v243, s35, v241
    ds_read_b128 v[224:227], v242 offset:0
    v_mfma_f32_16x16x32_bf16 v[108:111], v[228:231], v[216:219], v[108:111]
    s_add_u32 m0, s78, 64
    s_nop 0
    buffer_load_dwordx4 v245, s[16:19], s46 offen offset:1024 nt lds
    s_add_u32 s46, s46, 16384
    s_and_b32 s46, s46, 0x3ffff
    s_waitcnt lgkmcnt(3)
    v_mfma_f32_16x16x32_bf16 v[112:115], v[232:235], v[208:211], v[112:115]
    ds_read_b128 v[228:231], v244 offset:512
    v_mfma_f32_16x16x32_bf16 v[116:119], v[232:235], v[216:219], v[116:119]
    s_waitcnt lgkmcnt(2)
    v_mfma_f32_16x16x32_bf16 v[120:123], v[236:239], v[208:211], v[120:123]
    ds_read_b128 v[232:235], v242 offset:64
    v_mfma_f32_16x16x32_bf16 v[124:127], v[236:239], v[216:219], v[124:127]
    s_or_b64 vcc, vcc, s[92:93]
    s_cbranch_scc1 L_rare_b
L_back_b:
    s_sub_u32 s41, s41, 1
    s_cmp_lg_u32 s41, 0
    s_cbranch_scc1 L_p2
    s_waitcnt lgkmcnt(2)
    v_mfma_f32_16x16x32_bf16 v[208:211], v[224:227], v[128:131], 0
    ds_read_b128 v[236:239], v244 offset:576
    v_fma_f32 v192, v192, s42, v248
    v_fma_f32 v193, v193, s42, v248
    v_mfma_f32_16x16x32_bf16 v[216:219], v[224:227], v[160:163], 0
    v_exp_f32 v192, v192
    v_exp_f32 v193, v193
    s_waitcnt lgkmcnt(2)
    v_mfma_f32_16x16x32_bf16 v[212:215], v[228:231], v[128:131], 0
    ds_read_b128 v[224:227], v242 offset:128
    v_add_f32 v250, v250, v192
    v_add_f32 v250, v250, v193
    v_mfma_f32_16x16x32_bf16 v[220:223], v[228:231], v[160:163], 0
    v_cvt_pk_bf16_f32 v192, v192, v193
    v_fma_f32 v194, v194, s42, v248
    s_waitcnt lgkmcnt(2)
    v_mfma_f32_16x16x32_bf16 v[208:211], v[232:235], v[132:135], v[208:211]
    ds_read_b128 v[228:231], v244 offset:640
    v_fma_f32 v195, v195, s42, v248
    v_exp_f32 v194, v194
    v_mfma_f32_16x16x32_bf16 v[216:219], v[232:235], v[164:167], v[216:219]
    v_exp_f32 v195, v195
    s_waitcnt lgkmcnt(2)
    v_mfma_f32_16x16x32_bf16 v[212:215], v[236:239], v[132:135], v[212:215]
    ds_read_b128 v[232:235], v242 offset:192
    v_add_f32 v250, v250, v194
    v_add_f32 v250, v250, v195
    v_mfma_f32_16x16x32_bf16 v[220:223], v[236:239], v[164:167], v[220:223]
    v_cvt_pk_bf16_f32 v193, v194, v195
    v_fma_f32 v196, v196, s42, v248
    s_waitcnt lgkmcnt(2)
    v_mfma_f32_16x16x32_bf16 v[208:211], v[224:227], v[136:139], v[208:211]
    ds_read_b128 v[236:239], v244 offset:704
    v_fma_f32 v197, v197, s42, v248
    v_exp_f32 v196, v196
    v_mfma_f32_16x16x32_bf16 v[216:219], v[224:227], v[168:171], v[216:219]
    v_exp_f32 v197, v197
    v_add_f32 v250, v250, v196
    s_waitcnt lgkmcnt(2)
    v_mfma_f32_16x16x32_bf16 v[212:215], v[228:231], v[136:139], v[212:215]
    ds_read_b128 v[224:227], v242 offset:256
    v_add_f32 v250, v250, v197
    v_mfma_f32_16x16x32_bf16 v[220:223], v[228:231], v[168:171], v[220:223]
    v_cvt_pk_bf16_f32 v194, v196, v197
    v_fma_f32 v198, v198, s42, v248
    s_waitcnt lgkmcnt(2)
    v_mfma_f32_16x16x32_bf16 v[208:211], v[232:235], v[140:143], v[208:211]
    ds_read_b128 v[228:231], v244 offset:768
    v_fma_f32 v199, v199, s42, v248
    v_exp_f32 v198, v198
    v_mfma_f32_16x16x32_bf16 v[216:219], v[232:235], v[172:175], v[216:219]
    v_exp_f32 v199, v199
    v_add_f32 v250, v250, v198
    s_waitcnt lgkmcnt(2)
    v_mfma_f32_16x16x32_bf16 v[212:215], v[236:239], v[140:143], v[212:215]
    ds_read_b128 v[232:235], v242 offset:320
    v_add_f32 v250, v250, v199
    v_cvt_pk_bf16_f32 v195, v198, v199
    v_mfma_f32_16x16x32_bf16 v[220:223], v[236:239], v[172:175], v[220:223]
    v_fma_f32 v200, v200, s42, v249
    s_waitcnt lgkmcnt(2)
    v_mfma_f32_16x16x32_bf16 v[208:211], v[224:227], v[144:147], v[208:211]
    ds_read_b128 v[236:239], v244 offset:832
    v_fma_f32 v201, v201, s42, v249
    v_exp_f32 v200, v200
    v_mfma_f32_16x16x32_bf16 v[216:219], v[224:227], v[176:179], v[216:219]
    v_exp_f32 v201, v201
    v_add_f32 v251, v251, v200
    s_waitcnt lgkmcnt(2)
    v_mfma_f32_16x16x32_bf16 v[212:215], v[228:231], v[144:147], v[212:215]
    ds_read_b128 v[224:227], v242 offset:384
    v_add_f32 v251, v251, v201
    v_cvt_pk_bf16_f32 v200, v200, v201
    v_mfma_f32_16x16x32_bf16 v[220:223], v[228:231], v[176:179], v[220:223]
    v_fma_f32 v202, v202, s42, v249
    v_fma_f32 v203, v203, s42, v249
    s_waitcnt lgkmcnt(2)
    v_mfma_f32_16x16x32_bf16 v[208:211], v[232:235], v[148:151], v[208:211]
    ds_read_b128 v[228:231], v244 offset:896
    v_exp_f32 v202, v202
    v_mfma_f32_16x16x32_bf16 v[216:219], v[232:235], v[180:183], v[216:219]
    v_exp_f32 v203, v203
    v_add_f32 v251, v251, v202
    s_waitcnt lgkmcnt(2)
    v_mfma_f32_16x16x32_bf16 v[212:215], v[236:239], v[148:151], v[212:215]
    ds_read_b128 v[232:235], v242 offset:448
    v_add_f32 v251, v251, v203
    v_cvt_pk_bf16_f32 v201, v202, v203
    v_mfma_f32_16x16x32_bf16 v[220:223], v[236:239], v[180:183], v[220:223]
    v_fma_f32 v204, v204, s42, v249
    v_fma_f32 v205, v205, s42, v249
    s_waitcnt lgkmcnt(2)
    v_mfma_f32_16x16x32_bf16 v[208:211], v[224:227], v[152:155], v[208:211]
    ds_read_b128 v[236:239], v244 offset:960
    v_exp_f32 v204, v204
    v_exp_f32 v205, v205
    v_mfma_f32_16x16x32_bf16 v[216:219], v[224:227], v[184:187], v[216:219]
    v_add_f32 v251, v251, v204
    s_waitcnt lgkmcnt(2)
    v_mfma_f32_16x16x32_bf16 v[212:215], v[228:231], v[152:155], v[212:215]
    ds_read_b64_tr_b16 v[224:225], v243 offset:0
    ds_read_b64_tr_b16 v[226:227], v243 offset:512
    v_add_f32 v251, v251, v205
    v_cvt_pk_bf16_f32 v202, v204, v205
    v_mfma_f32_16x16x32_bf16 v[220:223], v[228:231], v[184:187], v[220:223]
    v_fma_f32 v206, v206, s42, v249
    v_fma_f32 v207, v207, s42, v249
    s_waitcnt lgkmcnt(3)
    v_mfma_f32_16x16x32_bf16 v[208:211], v[232:235], v[156:159], v[208:211]
    ds_read_b64_tr_b16 v[228:229], v243 offset:8
    ds_read_b64_tr_b16 v[230:231], v243 offset:520
    v_exp_f32 v206, v206
    v_exp_f32 v207, v207
    v_mfma_f32_16x16x32_bf16 v[216:219], v[232:235], v[188:191], v[216:219]
    v_add_f32 v251, v251, v206
    v_add_f32 v251, v251, v207
    s_waitcnt lgkmcnt(4)
    v_mfma_f32_16x16x32_bf16 v[212:215], v[236:239], v[156:159], v[212:215]
    ds_read_b64_tr_b16 v[232:233], v243 offset:64
    ds_read_b64_tr_b16 v[234:235], v243 offset:576
    v_cvt_pk_bf16_f32 v203, v206, v207
    v_mfma_f32_16x16x32_bf16 v[220:223], v[236:239], v[188:191], v[220:223]
    s_waitcnt lgkmcnt(4)
    v_mfma_f32_16x16x32_bf16 v[0:3], v[224:227], v[192:195], v[0:3]
    ds_read_b64_tr_b16 v[236:237], v243 offset:72
    ds_read_b64_tr_b16 v[238:239], v243 offset:584
    v_mfma_f32_16x16x32_bf16 v[4:7], v[224:227], v[200:203], v[4:7]
    s_waitcnt lgkmcnt(4)
    v_mfma_f32_16x16x32_bf16 v[8:11], v[228:231], v[192:195], v[8:11]
    ds_read_b64_tr_b16 v[224:225], v243 offset:128
    ds_read_b64_tr_b16 v[226:227], v243 offset:640
    v_mfma_f32_16x16x32_bf16 v[12:15], v[228:231], v[200:203], v[12:15]
    s_waitcnt lgkmcnt(4)
    v_mfma_f32_16x16x32_bf16 v[16:19], v[232:235], v[192:195], v[16:19]
    ds_read_b64_tr_b16 v[228:229], v243 offset:136
    ds_read_b64_tr_b16 v[230:231], v243 offset:648
    v_mfma_f32_16x16x32_bf16 v[20:23], v[232:235], v[200:203], v[20:23]
    s_waitcnt lgkmcnt(4)
    v_mfma_f32_16x16x32_bf16 v[24:27], v[236:239], v[192:195], v[24:27]
    ds_read_b64_tr_b16 v[232:233], v243 offset:192
    ds_read_b64_tr_b16 v[234:235], v243 offset:704
    v_mfma_f32_16x16x32_bf16 v[28:31], v[236:239], v[200:203], v[28:31]
    s_waitcnt vmcnt(4)
    s_barrier
    s_add_u32 s55, s36, s48
    s_add_u32 s78, s36, s49
    s_add_u32 s36, s36, 34816
    s_cmp_ge_u32 s36, 139264
    s_cselect_b32 s40, 139264, 0
    s_sub_u32 s36, s36, s40
    s_waitcnt lgkmcnt(4)
    v_mfma_f32_16x16x32_bf16 v[32:35], v[224:227], v[192:195], v[32:35]
    ds_read_b64_tr_b16 v[236:237], v243 offset:200
    ds_read_b64_tr_b16 v[238:239], v243 offset:712
    v_mfma_f32_16x16x32_bf16 v[36:39], v[224:227], v[200:203], v[36:39]
    s_waitcnt lgkmcnt(4)
    v_mfma_f32_16x16x32_bf16 v[40:43], v[228:231], v[192:195], v[40:43]
    ds_read_b64_tr_b16 v[224:225], v243 offset:256
    ds_read_b64_tr_b16 v[226:227], v243 offset:768
    v_max3_f32 v252, v208, v209, v210
    v_mfma_f32_16x16x32_bf16 v[44:47], v[228:231], v[200:203], v[44:47]
    v_max3_f32 v252, v252, v211, v212
    s_waitcnt lgkmcnt(4)
    v_mfma_f32_16x16x32_bf16 v[48:51], v[232:235], v[192:195], v[48:51]
    ds_read_b64_tr_b16 v[228:229], v243 offset:264
    ds_read_b64_tr_b16 v[230:231], v243 offset:776
    s_add_u32 m0, s78, 0
    s_nop 0
    buffer_load_dwordx4 v245, s[16:19], s46 offen nt lds
    v_max3_f32 v252, v252, v213, v214
    v_mfma_f32_16x16x32_bf16 v[52:55], v[232:235], v[200:203], v[52:55]
    s_waitcnt lgkmcnt(4)
    v_mfma_f32_16x16x32_bf16 v[56:59], v[236:239], v[192:195], v[56:59]
    ds_read_b64_tr_b16 v[232:233], v243 offset:320
    ds_read_b64_tr_b16 v[234:235], v243 offset:832
    v_max_f32 v252, v252, v215
    v_mfma_f32_16x16x32_bf16 v[60:63], v[236:239], v[200:203], v[60:63]
    v_max3_f32 v253, v216, v217, v218
    s_waitcnt lgkmcnt(4)
    v_mfma_f32_16x16x32_bf16 v[64:67], v[224:227], v[192:195], v[64:67]
    ds_read_b64_tr_b16 v[236:237], v243 offset:328
    ds_read_b64_tr_b16 v[238:239], v243 offset:840
    v_max3_f32 v253, v253, v219, v220
    v_mfma_f32_16x16x32_bf16 v[68:71], v[224:227], v[200:203], v[68:71]
    s_add_u32 m0, s78, 64
    s_nop 0
    buffer_load_dwordx4 v245, s[16:19], s46 offen offset:1024 nt lds
    s_add_u32 s46, s46, 16384
    s_and_b32 s46, s46, 0x3ffff
    s_waitcnt lgkmcnt(4)
    v_mfma_f32_16x16x32_bf16 v[72:75], v[228:231], v[192:195], v[72:75]
    ds_read_b64_tr_b16 v[224:225], v243 offset:384
    ds_read_b64_tr_b16 v[226:227], v243 offset:896
    v_max3_f32 v253, v253, v221, v222
    v_mfma_f32_16x16x32_bf16 v[76:79], v[228:231], v[200:203], v[76:79]
    v_max_f32 v253, v253, v223
    s_waitcnt lgkmcnt(4)
    v_mfma_f32_16x16x32_bf16 v[80:83], v[232:235], v[192:195], v[80:83]
    ds_read_b64_tr_b16 v[228:229], v243 offset:392
    ds_read_b64_tr_b16 v[230:231], v243 offset:904
    v_fma_f32 v254, v252, s42, v248
    v_mfma_f32_16x16x32_bf16 v[84:87], v[232:235], v[200:203], v[84:87]
    s_waitcnt lgkmcnt(4)
    v_mfma_f32_16x16x32_bf16 v[88:91], v[236:239], v[192:195], v[88:91]
    ds_read_b64_tr_b16 v[232:233], v243 offset:448
    ds_read_b64_tr_b16 v[234:235], v243 offset:960
    v_cmp_lt_f32 s[92:93], s44, v254
    v_mfma_f32_16x16x32_bf16 v[92:95], v[236:239], v[200:203], v[92:95]
    v_fma_f32 v254, v253, s42, v249
    s_waitcnt lgkmcnt(4)
    v_mfma_f32_16x16x32_bf16 v[96:99], v[224:227], v[192:195], v[96:99]
    ds_read_b64_tr_b16 v[236:237], v243 offset:456
    ds_read_b64_tr_b16 v[238:239], v243 offset:968
    v_cmp_lt_f32 vcc, s44, v254
    v_mfma_f32_16x16x32_bf16 v[100:103], v[224:227], v[200:203], v[100:103]
    s_waitcnt lgkmcnt(4)
    v_mfma_f32_16x16x32_bf16 v[104:107], v[228:231], v[192:195], v[104:107]
    s_add_u32 s35, s35, 34816
    s_cmp_ge_u32 s35, 139264
    s_cselect_b32 s40, 139264, 0
    s_sub_u32 s35, s35, s40
    v_add_u32 v242, s35, v240
    v_xor_b32 v244, 16, v242
    v_add_u32 v243, s35, v241
    ds_read_b128 v[224:227], v242 offset:0
    v_mfma_f32_16x16x32_bf16 v[108:111], v[228:231], v[200:203], v[108:111]
    s_waitcnt lgkmcnt(3)
    v_mfma_f32_16x16x32_bf16 v[112:115], v[232:235], v[192:195], v[112:115]
    ds_read_b128 v[228:231], v244 offset:512
    v_mfma_f32_16x16x32_bf16 v[116:119], v[232:235], v[200:203], v[116:119]
    s_waitcnt lgkmcnt(2)
    v_mfma_f32_16x16x32_bf16 v[120:123], v[236:239], v[192:195], v[120:123]
    ds_read_b128 v[232:235], v242 offset:64
    v_mfma_f32_16x16x32_bf16 v[124:127], v[236:239], v[200:203], v[124:127]
    s_or_b64 vcc, vcc, s[92:93]
    s_cbranch_scc1 L_rare_c
L_back_c:
    s_waitcnt lgkmcnt(2)
    v_mfma_f32_16x16x32_bf16 v[192:195], v[224:227], v[128:131], 0
    ds_read_b128 v[236:239], v244 offset:576
    v_fma_f32 v208, v208, s42, v248
    v_fma_f32 v209, v209, s42, v248
    v_mfma_f32_16x16x32_bf16 v[200:203], v[224:227], v[160:163], 0
    v_exp_f32 v208, v208
    v_exp_f32 v209, v209
    s_waitcnt lgkmcnt(2)
    v_mfma_f32_16x16x32_bf16 v[196:199], v[228:231], v[128:131], 0
    ds_read_b128 v[224:227], v242 offset:128
    v_add_f32 v250, v250, v208
    v_add_f32 v250, v250, v209
    v_mfma_f32_16x16x32_bf16 v[204:207], v[228:231], v[160:163], 0
    v_cvt_pk_bf16_f32 v208, v208, v209
    v_fma_f32 v210, v210, s42, v248
    s_waitcnt lgkmcnt(2)
    v_mfma_f32_16x16x32_bf16 v[192:195], v[232:235], v[132:135], v[192:195]
    ds_read_b128 v[228:231], v244 offset:640
    v_fma_f32 v211, v211, s42, v248
    v_exp_f32 v210, v210
    v_mfma_f32_16x16x32_bf16 v[200:203], v[232:235], v[164:167], v[200:203]
    v_exp_f32 v211, v211
    s_waitcnt lgkmcnt(2)
    v_mfma_f32_16x16x32_bf16 v[196:199], v[236:239], v[132:135], v[196:199]
    ds_read_b128 v[232:235], v242 offset:192
    v_add_f32 v250, v250, v210
    v_add_f32 v250, v250, v211
    v_mfma_f32_16x16x32_bf16 v[204:207], v[236:239], v[164:167], v[204:207]
    v_cvt_pk_bf16_f32 v209, v210, v211
    v_fma_f32 v212, v212, s42, v248
    s_waitcnt lgkmcnt(2)
    v_mfma_f32_16x16x32_bf16 v[192:195], v[224:227], v[136:139], v[192:195]
    ds_read_b128 v[236:239], v244 offset:704
    v_fma_f32 v213, v213, s42, v248
    v_exp_f32 v212, v212
    v_mfma_f32_16x16x32_bf16 v[200:203], v[224:227], v[168:171], v[200:203]
    v_exp_f32 v213, v213
    v_add_f32 v250, v250, v212
    s_waitcnt lgkmcnt(2)
    v_mfma_f32_16x16x32_bf16 v[196:199], v[228:231], v[136:139], v[196:199]
    ds_read_b128 v[224:227], v242 offset:256
    v_add_f32 v250, v250, v213
    v_mfma_f32_16x16x32_bf16 v[204:207], v[228:231], v[168:171], v[204:207]
    v_cvt_pk_bf16_f32 v210, v212, v213
    v_fma_f32 v214, v214, s42, v248
    s_waitcnt lgkmcnt(2)
    v_mfma_f32_16x16x32_bf16 v[192:195], v[232:235], v[140:143], v[192:195]
    ds_read_b128 v[228:231], v244 offset:768
    v_fma_f32 v215, v215, s42, v248
    v_exp_f32 v214, v214
    v_mfma_f32_16x16x32_bf16 v[200:203], v[232:235], v[172:175], v[200:203]
    v_exp_f32 v215, v215
    v_add_f32 v250, v250, v214
    s_waitcnt lgkmcnt(2)
    v_mfma_f32_16x16x32_bf16 v[196:199], v[236:239], v[140:143], v[196:199]
    ds_read_b128 v[232:235], v242 offset:320
    v_add_f32 v250, v250, v215
    v_cvt_pk_bf16_f32 v211, v214, v215
    v_mfma_f32_16x16x32_bf16 v[204:207], v[236:239], v[172:175], v[204:207]
    v_fma_f32 v216, v216, s42, v249
    s_waitcnt lgkmcnt(2)
    v_mfma_f32_16x16x32_bf16 v[192:195], v[224:227], v[144:147], v[192:195]
    ds_read_b128 v[236:239], v244 offset:832
    v_fma_f32 v217, v217, s42, v249
    v_exp_f32 v216, v216
    v_mfma_f32_16x16x32_bf16 v[200:203], v[224:227], v[176:179], v[200:203]
    v_exp_f32 v217, v217
    v_add_f32 v251, v251, v216
    s_waitcnt lgkmcnt(2)
    v_mfma_f32_16x16x32_bf16 v[196:199], v[228:231], v[144:147], v[196:199]
    ds_read_b128 v[224:227], v242 offset:384
    v_add_f32 v251, v251, v217
    v_cvt_pk_bf16_f32 v216, v216, v217
    v_mfma_f32_16x16x32_bf16 v[204:207], v[228:231], v[176:179], v[204:207]
    v_fma_f32 v218, v218, s42, v249
    v_fma_f32 v219, v219, s42, v249
    s_waitcnt lgkmcnt(2)
    v_mfma_f32_16x16x32_bf16 v[192:195], v[232:235], v[148:151], v[192:195]
    ds_read_b128 v[228:231], v244 offset:896
    v_exp_f32 v218, v218
    v_mfma_f32_16x16x32_bf16 v[200:203], v[232:235], v[180:183], v[200:203]
    v_exp_f32 v219, v219
    v_add_f32 v251, v251, v218
    s_waitcnt lgkmcnt(2)
    v_mfma_f32_16x16x32_bf16 v[196:199], v[236:239], v[148:151], v[196:199]
    ds_read_b128 v[232:235], v242 offset:448
    v_add_f32 v251, v251, v219
    v_cvt_pk_bf16_f32 v217, v218, v219
    v_mfma_f32_16x16x32_bf16 v[204:207], v[236:239], v[180:183], v[204:207]
    v_fma_f32 v220, v220, s42, v249
    v_fma_f32 v221, v221, s42, v249
    s_waitcnt lgkmcnt(2)
    v_mfma_f32_16x16x32_bf16 v[192:195], v[224:227], v[152:155], v[192:195]
    ds_read_b128 v[236:239], v244 offset:960
    v_exp_f32 v220, v220
    v_exp_f32 v221, v221
    v_mfma_f32_16x16x32_bf16 v[200:203], v[224:227], v[184:187], v[200:203]
    v_add_f32 v251, v251, v220
    s_waitcnt lgkmcnt(2)
    v_mfma_f32_16x16x32_bf16 v[196:199], v[228:231], v[152:155], v[196:199]
    ds_read_b64_tr_b16 v[224:225], v243 offset:0
    ds_read_b64_tr_b16 v[226:227], v243 offset:512
    v_add_f32 v251, v251, v221
    v_cvt_pk_bf16_f32 v218, v220, v221
    v_mfma_f32_16x16x32_bf16 v[204:207], v[228:231], v[184:187], v[204:207]
    v_fma_f32 v222, v222, s42, v249
    v_fma_f32 v223, v223, s42, v249
    s_waitcnt lgkmcnt(3)
    v_mfma_f32_16x16x32_bf16 v[192:195], v[232:235], v[156:159], v[192:195]
    ds_read_b64_tr_b16 v[228:229], v243 offset:8
    ds_read_b64_tr_b16 v[230:231], v243 offset:520
    v_exp_f32 v222, v222
    v_exp_f32 v223, v223
    v_mfma_f32_16x16x32_bf16 v[200:203], v[232:235], v[188:191], v[200:203]
    v_add_f32 v251, v251, v222
    v_add_f32 v251, v251, v223
    s_waitcnt lgkmcnt(4)
    v_mfma_f32_16x16x32_bf16 v[196:199], v[236:239], v[156:159], v[196:199]
    ds_read_b64_tr_b16 v[232:233], v243 offset:64
    ds_read_b64_tr_b16 v[234:235], v243 offset:576
    v_cvt_pk_bf16_f32 v219, v222, v223
    v_mfma_f32_16x16x32_bf16 v[204:207], v[236:239], v[188:191], v[204:207]
    s_waitcnt lgkmcnt(4)
    v_mfma_f32_16x16x32_bf16 v[0:3], v[224:227], v[208:211], v[0:3]
    ds_read_b64_tr_b16 v[236:237], v243 offset:72
    ds_read_b64_tr_b16 v[238:239], v243 offset:584
    v_mfma_f32_16x16x32_bf16 v[4:7], v[224:227], v[216:219], v[4:7]
    s_waitcnt lgkmcnt(4)
    v_mfma_f32_16x16x32_bf16 v[8:11], v[228:231], v[208:211], v[8:11]
    ds_read_b64_tr_b16 v[224:225], v243 offset:128
    ds_read_b64_tr_b16 v[226:227], v243 offset:640
    v_mfma_f32_16x16x32_bf16 v[12:15], v[228:231], v[216:219], v[12:15]
    s_waitcnt lgkmcnt(4)
    v_mfma_f32_16x16x32_bf16 v[16:19], v[232:235], v[208:211], v[16:19]
    ds_read_b64_tr_b16 v[228:229], v243 offset:136
    ds_read_b64_tr_b16 v[230:231], v243 offset:648
    v_mfma_f32_16x16x32_bf16 v[20:23], v[232:235], v[216:219], v[20:23]
    s_waitcnt lgkmcnt(4)
    v_mfma_f32_16x16x32_bf16 v[24:27], v[236:239], v[208:211], v[24:27]
    ds_read_b64_tr_b16 v[232:233], v243 offset:192
    ds_read_b64_tr_b16 v[234:235], v243 offset:704
    v_mfma_f32_16x16x32_bf16 v[28:31], v[236:239], v[216:219], v[28:31]
    s_waitcnt vmcnt(2)
    s_barrier
    v_bfe_u32 v253, v255, 4, 1
    v_lshlrev_b32 v253, 1, v253
    v_and_b32 v252, 7, v255
    v_xor_b32 v253, v253, v252
    v_lshlrev_b32 v253, 4, v253
    v_lshrrev_b32 v252, 3, v255
    v_mul_u32_u24 v252, 896, v252
    v_add_u32 v247, v253, v252
    v_xor_b32 v253, 64, v253
    v_add_u32 v246, v253, v252
    s_lshl_b32 s50, s32, 11
    s_mul_i32 s47, s32, 14336
    s_add_u32 s55, s36, s50
    s_add_u32 s36, s36, 34816
    s_cmp_ge_u32 s36, 139264
    s_cselect_b32 s40, 139264, 0
    s_sub_u32 s36, s36, s40
    s_waitcnt lgkmcnt(4)
    v_mfma_f32_16x16x32_bf16 v[32:35], v[224:227], v[208:211], v[32:35]
    ds_read_b64_tr_b16 v[236:237], v243 offset:200
    ds_read_b64_tr_b16 v[238:239], v243 offset:712
    v_mfma_f32_16x16x32_bf16 v[36:39], v[224:227], v[216:219], v[36:39]
    s_waitcnt lgkmcnt(4)
    v_mfma_f32_16x16x32_bf16 v[40:43], v[228:231], v[208:211], v[40:43]
    ds_read_b64_tr_b16 v[224:225], v243 offset:256
    ds_read_b64_tr_b16 v[226:227], v243 offset:768
    v_max3_f32 v252, v192, v193, v194
    v_mfma_f32_16x16x32_bf16 v[44:47], v[228:231], v[216:219], v[44:47]
    v_max3_f32 v252, v252, v195, v196
    s_waitcnt lgkmcnt(4)
    v_mfma_f32_16x16x32_bf16 v[48:51], v[232:235], v[208:211], v[48:51]
    ds_read_b64_tr_b16 v[228:229], v243 offset:264
    ds_read_b64_tr_b16 v[230:231], v243 offset:776
    s_add_u32 s38, s47, 0
    s_add_u32 m0, s55, 0
    s_nop 0
    buffer_load_dwordx4 v247, s[24:27], s38 offen lds
    v_max3_f32 v252, v252, v197, v198
    v_mfma_f32_16x16x32_bf16 v[52:55], v[232:235], v[216:219], v[52:55]
    s_waitcnt lgkmcnt(4)
    v_mfma_f32_16x16x32_bf16 v[56:59], v[236:239], v[208:211], v[56:59]
    ds_read_b64_tr_b16 v[232:233], v243 offset:320
    ds_read_b64_tr_b16 v[234:235], v243 offset:832
    v_max_f32 v252, v252, v199
    v_mfma_f32_16x16x32_bf16 v[60:63], v[236:239], v[216:219], v[60:63]
    v_max3_f32 v253, v200, v201, v202
    s_waitcnt lgkmcnt(4)
    v_mfma_f32_16x16x32_bf16 v[64:67], v[224:227], v[208:211], v[64:67]
    ds_read_b64_tr_b16 v[236:237], v243 offset:328
    ds_read_b64_tr_b16 v[238:239], v243 offset:840
    v_max3_f32 v253, v253, v203, v204
    v_mfma_f32_16x16x32_bf16 v[68:71], v[224:227], v[216:219], v[68:71]
    s_add_u32 s38, s47, 7168
    s_add_u32 m0, s55, 1024
    s_nop 0
    buffer_load_dwordx4 v246, s[24:27], s38 offen lds
    s_waitcnt lgkmcnt(4)
    v_mfma_f32_16x16x32_bf16 v[72:75], v[228:231], v[208:211], v[72:75]
    ds_read_b64_tr_b16 v[224:225], v243 offset:384
    ds_read_b64_tr_b16 v[226:227], v243 offset:896
    v_max3_f32 v253, v253, v205, v206
    v_mfma_f32_16x16x32_bf16 v[76:79], v[228:231], v[216:219], v[76:79]
    v_max_f32 v253, v253, v207
    s_waitcnt lgkmcnt(4)
    v_mfma_f32_16x16x32_bf16 v[80:83], v[232:235], v[208:211], v[80:83]
    ds_read_b64_tr_b16 v[228:229], v243 offset:392
    ds_read_b64_tr_b16 v[230:231], v243 offset:904
    v_fma_f32 v254, v252, s42, v248
    v_mfma_f32_16x16x32_bf16 v[84:87], v[232:235], v[216:219], v[84:87]
    s_waitcnt lgkmcnt(4)
    v_mfma_f32_16x16x32_bf16 v[88:91], v[236:239], v[208:211], v[88:91]
    ds_read_b64_tr_b16 v[232:233], v243 offset:448
    ds_read_b64_tr_b16 v[234:235], v243 offset:960
    s_add_u32 s38, s47, 229376
    s_add_u32 m0, s55, 17408
    s_nop 0
    buffer_load_dwordx4 v247, s[24:27], s38 offen lds
    v_cmp_lt_f32 s[92:93], s44, v254
    v_mfma_f32_16x16x32_bf16 v[92:95], v[236:239], v[216:219], v[92:95]
    v_fma_f32 v254, v253, s42, v249
    s_waitcnt lgkmcnt(4)
    v_mfma_f32_16x16x32_bf16 v[96:99], v[224:227], v[208:211], v[96:99]
    ds_read_b64_tr_b16 v[236:237], v243 offset:456
    ds_read_b64_tr_b16 v[238:239], v243 offset:968
    v_cmp_lt_f32 vcc, s44, v254
    v_mfma_f32_16x16x32_bf16 v[100:103], v[224:227], v[216:219], v[100:103]
    s_waitcnt lgkmcnt(4)
    v_mfma_f32_16x16x32_bf16 v[104:107], v[228:231], v[208:211], v[104:107]
    s_add_u32 s35, s35, 34816
    s_cmp_ge_u32 s35, 139264
    s_cselect_b32 s40, 139264, 0
    s_sub_u32 s35, s35, s40
    v_add_u32 v242, s35, v240
    v_xor_b32 v244, 16, v242
    v_add_u32 v243, s35, v241
    ds_read_b128 v[224:227], v242 offset:0
    v_mfma_f32_16x16x32_bf16 v[108:111], v[228:231], v[216:219], v[108:111]
    s_add_u32 s38, s47, 236544
    s_add_u32 m0, s55, 18432
    s_nop 0
    buffer_load_dwordx4 v246, s[24:27], s38 offen lds
    s_waitcnt lgkmcnt(3)
    v_mfma_f32_16x16x32_bf16 v[112:115], v[232:235], v[208:211], v[112:115]
    ds_read_b128 v[228:231], v244 offset:512
    v_mfma_f32_16x16x32_bf16 v[116:119], v[232:235], v[216:219], v[116:119]
    s_waitcnt lgkmcnt(2)
    v_mfma_f32_16x16x32_bf16 v[120:123], v[236:239], v[208:211], v[120:123]
    ds_read_b128 v[232:235], v242 offset:64
    v_mfma_f32_16x16x32_bf16 v[124:127], v[236:239], v[216:219], v[124:127]
    s_or_b64 vcc, vcc, s[92:93]
    s_cbranch_scc1 L_rare_d
L_back_d:
    s_waitcnt lgkmcnt(2)
    v_mfma_f32_16x16x32_bf16 v[208:211], v[224:227], v[128:131], 0
    ds_read_b128 v[236:239], v244 offset:576
    v_fma_f32 v192, v192, s42, v248
    v_fma_f32 v193, v193, s42, v248
    v_mfma_f32_16x16x32_bf16 v[216:219], v[224:227], v[160:163], 0
    v_exp_f32 v192, v192
    v_exp_f32 v193, v193
    s_waitcnt lgkmcnt(2)
    v_mfma_f32_16x16x32_bf16 v[212:215], v[228:231], v[128:131], 0
    ds_read_b128 v[224:227], v242 offset:128
    v_add_f32 v250, v250, v192
    v_add_f32 v250, v250, v193
    v_mfma_f32_16x16x32_bf16 v[220:223], v[228:231], v[160:163], 0
    v_cvt_pk_bf16_f32 v192, v192, v193
    v_fma_f32 v194, v194, s42, v248
    s_waitcnt lgkmcnt(2)
    v_mfma_f32_16x16x32_bf16 v[208:211], v[232:235], v[132:135], v[208:211]
    ds_read_b128 v[228:231], v244 offset:640
    v_fma_f32 v195, v195, s42, v248
    v_exp_f32 v194, v194
    v_mfma_f32_16x16x32_bf16 v[216:219], v[232:235], v[164:167], v[216:219]
    v_exp_f32 v195, v195
    s_waitcnt lgkmcnt(2)
    v_mfma_f32_16x16x32_bf16 v[212:215], v[236:239], v[132:135], v[212:215]
    ds_read_b128 v[232:235], v242 offset:192
    v_add_f32 v250, v250, v194
    v_add_f32 v250, v250, v195
    v_mfma_f32_16x16x32_bf16 v[220:223], v[236:239], v[164:167], v[220:223]
    v_cvt_pk_bf16_f32 v193, v194, v195
    v_fma_f32 v196, v196, s42, v248
    s_waitcnt lgkmcnt(2)
    v_mfma_f32_16x16x32_bf16 v[208:211], v[224:227], v[136:139], v[208:211]
    ds_read_b128 v[236:239], v244 offset:704
    v_fma_f32 v197, v197, s42, v248
    v_exp_f32 v196, v196
    v_mfma_f32_16x16x32_bf16 v[216:219], v[224:227], v[168:171], v[216:219]
    v_exp_f32 v197, v197
    v_add_f32 v250, v250, v196
    s_waitcnt lgkmcnt(2)
    v_mfma_f32_16x16x32_bf16 v[212:215], v[228:231], v[136:139], v[212:215]
    ds_read_b128 v[224:227], v242 offset:256
    v_add_f32 v250, v250, v197
    v_mfma_f32_16x16x32_bf16 v[220:223], v[228:231], v[168:171], v[220:223]
    v_cvt_pk_bf16_f32 v194, v196, v197
    v_fma_f32 v198, v198, s42, v248
    s_waitcnt lgkmcnt(2)
    v_mfma_f32_16x16x32_bf16 v[208:211], v[232:235], v[140:143], v[208:211]
    ds_read_b128 v[228:231], v244 offset:768
    v_fma_f32 v199, v199, s42, v248
    v_exp_f32 v198, v198
    v_mfma_f32_16x16x32_bf16 v[216:219], v[232:235], v[172:175], v[216:219]
    v_exp_f32 v199, v199
    v_add_f32 v250, v250, v198
    s_waitcnt lgkmcnt(2)
    v_mfma_f32_16x16x32_bf16 v[212:215], v[236:239], v[140:143], v[212:215]
    ds_read_b128 v[232:235], v242 offset:320
    v_add_f32 v250, v250, v199
    v_cvt_pk_bf16_f32 v195, v198, v199
    v_mfma_f32_16x16x32_bf16 v[220:223], v[236:239], v[172:175], v[220:223]
    v_fma_f32 v200, v200, s42, v249
    s_waitcnt lgkmcnt(2)
    v_mfma_f32_16x16x32_bf16 v[208:211], v[224:227], v[144:147], v[208:211]
    ds_read_b128 v[236:239], v244 offset:832
    v_fma_f32 v201, v201, s42, v249
    v_exp_f32 v200, v200
    v_mfma_f32_16x16x32_bf16 v[216:219], v[224:227], v[176:179], v[216:219]
    v_exp_f32 v201, v201
    v_add_f32 v251, v251, v200
    s_waitcnt lgkmcnt(2)
    v_mfma_f32_16x16x32_bf16 v[212:215], v[228:231], v[144:147], v[212:215]
    ds_read_b128 v[224:227], v242 offset:384
    v_add_f32 v251, v251, v201
    v_cvt_pk_bf16_f32 v200, v200, v201
    v_mfma_f32_16x16x32_bf16 v[220:223], v[228:231], v[176:179], v[220:223]
    v_fma_f32 v202, v202, s42, v249
    v_fma_f32 v203, v203, s42, v249
    s_waitcnt lgkmcnt(2)
    v_mfma_f32_16x16x32_bf16 v[208:211], v[232:235], v[148:151], v[208:211]
    ds_read_b128 v[228:231], v244 offset:896
    v_exp_f32 v202, v202
    v_mfma_f32_16x16x32_bf16 v[216:219], v[232:235], v[180:183], v[216:219]
    v_exp_f32 v203, v203
    v_add_f32 v251, v251, v202
    s_waitcnt lgkmcnt(2)
    v_mfma_f32_16x16x32_bf16 v[212:215], v[236:239], v[148:151], v[212:215]
    ds_read_b128 v[232:235], v242 offset:448
    v_add_f32 v251, v251, v203
    v_cvt_pk_bf16_f32 v201, v202, v203
    v_mfma_f32_16x16x32_bf16 v[220:223], v[236:239], v[180:183], v[220:223]
    v_fma_f32 v204, v204, s42, v249
    v_fma_f32 v205, v205, s42, v249
    s_waitcnt lgkmcnt(2)
    v_mfma_f32_16x16x32_bf16 v[208:211], v[224:227], v[152:155], v[208:211]
    ds_read_b128 v[236:239], v244 offset:960
    v_exp_f32 v204, v204
    v_exp_f32 v205, v205
    v_mfma_f32_16x16x32_bf16 v[216:219], v[224:227], v[184:187], v[216:219]
    v_add_f32 v251, v251, v204
    s_waitcnt lgkmcnt(2)
    v_mfma_f32_16x16x32_bf16 v[212:215], v[228:231], v[152:155], v[212:215]
    ds_read_b64_tr_b16 v[224:225], v243 offset:0
    ds_read_b64_tr_b16 v[226:227], v243 offset:512
    v_add_f32 v251, v251, v205
    v_cvt_pk_bf16_f32 v202, v204, v205
    v_mfma_f32_16x16x32_bf16 v[220:223], v[228:231], v[184:187], v[220:223]
    v_fma_f32 v206, v206, s42, v249
    v_fma_f32 v207, v207, s42, v249
    s_waitcnt lgkmcnt(3)
    v_mfma_f32_16x16x32_bf16 v[208:211], v[232:235], v[156:159], v[208:211]
    ds_read_b64_tr_b16 v[228:229], v243 offset:8
    ds_read_b64_tr_b16 v[230:231], v243 offset:520
    v_exp_f32 v206, v206
    v_exp_f32 v207, v207
    v_mfma_f32_16x16x32_bf16 v[216:219], v[232:235], v[188:191], v[216:219]
    v_add_f32 v251, v251, v206
    v_add_f32 v251, v251, v207
    s_waitcnt lgkmcnt(4)
    v_mfma_f32_16x16x32_bf16 v[212:215], v[236:239], v[156:159], v[212:215]
    ds_read_b64_tr_b16 v[232:233], v243 offset:64
    ds_read_b64_tr_b16 v[234:235], v243 offset:576
    v_cvt_pk_bf16_f32 v203, v206, v207
    v_mfma_f32_16x16x32_bf16 v[220:223], v[236:239], v[188:191], v[220:223]
    s_waitcnt lgkmcnt(4)
    v_mfma_f32_16x16x32_bf16 v[0:3], v[224:227], v[192:195], v[0:3]
    ds_read_b64_tr_b16 v[236:237], v243 offset:72
    ds_read_b64_tr_b16 v[238:239], v243 offset:584
    v_mfma_f32_16x16x32_bf16 v[4:7], v[224:227], v[200:203], v[4:7]
    s_waitcnt lgkmcnt(4)
    v_mfma_f32_16x16x32_bf16 v[8:11], v[228:231], v[192:195], v[8:11]
    ds_read_b64_tr_b16 v[224:225], v243 offset:128
    ds_read_b64_tr_b16 v[226:227], v243 offset:640
    v_mfma_f32_16x16x32_bf16 v[12:15], v[228:231], v[200:203], v[12:15]
    s_waitcnt lgkmcnt(4)
    v_mfma_f32_16x16x32_bf16 v[16:19], v[232:235], v[192:195], v[16:19]
    ds_read_b64_tr_b16 v[228:229], v243 offset:136
    ds_read_b64_tr_b16 v[230:231], v243 offset:648
    v_mfma_f32_16x16x32_bf16 v[20:23], v[232:235], v[200:203], v[20:23]
    s_waitcnt lgkmcnt(4)
    v_mfma_f32_16x16x32_bf16 v[24:27], v[236:239], v[192:195], v[24:27]
    ds_read_b64_tr_b16 v[232:233], v243 offset:192
    ds_read_b64_tr_b16 v[234:235], v243 offset:704
    v_mfma_f32_16x16x32_bf16 v[28:31], v[236:239], v[200:203], v[28:31]
    s_waitcnt vmcnt(4)
    s_barrier
    s_add_u32 s55, s36, s50
    s_add_u32 s36, s36, 34816
    s_cmp_ge_u32 s36, 139264
    s_cselect_b32 s40, 139264, 0
    s_sub_u32 s36, s36, s40
    s_waitcnt lgkmcnt(4)
    v_mfma_f32_16x16x32_bf16 v[32:35], v[224:227], v[192:195], v[32:35]
    ds_read_b64_tr_b16 v[236:237], v243 offset:200
    ds_read_b64_tr_b16 v[238:239], v243 offset:712
    v_mfma_f32_16x16x32_bf16 v[36:39], v[224:227], v[200:203], v[36:39]
    s_waitcnt lgkmcnt(4)
    v_mfma_f32_16x16x32_bf16 v[40:43], v[228:231], v[192:195], v[40:43]
    ds_read_b64_tr_b16 v[224:225], v243 offset:256
    ds_read_b64_tr_b16 v[226:227], v243 offset:768
    v_max3_f32 v252, v208, v209, v210
    v_mfma_f32_16x16x32_bf16 v[44:47], v[228:231], v[200:203], v[44:47]
    v_max3_f32 v252, v252, v211, v212
    s_waitcnt lgkmcnt(4)
    v_mfma_f32_16x16x32_bf16 v[48:51], v[232:235], v[192:195], v[48:51]
    ds_read_b64_tr_b16 v[228:229], v243 offset:264
    ds_read_b64_tr_b16 v[230:231], v243 offset:776
    s_add_u32 s38, s47, 114688
    s_add_u32 m0, s55, 0
    s_nop 0
    buffer_load_dwordx4 v247, s[24:27], s38 offen lds
    v_max3_f32 v252, v252, v213, v214
    v_mfma_f32_16x16x32_bf16 v[52:55], v[232:235], v[200:203], v[52:55]
    s_waitcnt lgkmcnt(4)
    v_mfma_f32_16x16x32_bf16 v[56:59], v[236:239], v[192:195], v[56:59]
    ds_read_b64_tr_b16 v[232:233], v243 offset:320
    ds_read_b64_tr_b16 v[234:235], v243 offset:832
    v_max_f32 v252, v252, v215
    v_mfma_f32_16x16x32_bf16 v[60:63], v[236:239], v[200:203], v[60:63]
    v_max3_f32 v253, v216, v217, v218
    s_waitcnt lgkmcnt(4)
    v_mfma_f32_16x16x32_bf16 v[64:67], v[224:227], v[192:195], v[64:67]
    ds_read_b64_tr_b16 v[236:237], v243 offset:328
    ds_read_b64_tr_b16 v[238:239], v243 offset:840
    v_max3_f32 v253, v253, v219, v220
    v_mfma_f32_16x16x32_bf16 v[68:71], v[224:227], v[200:203], v[68:71]
    s_add_u32 s38, s47, 121856
    s_add_u32 m0, s55, 1024
    s_nop 0
    buffer_load_dwordx4 v246, s[24:27], s38 offen lds
    s_waitcnt lgkmcnt(4)
    v_mfma_f32_16x16x32_bf16 v[72:75], v[228:231], v[192:195], v[72:75]
    ds_read_b64_tr_b16 v[224:225], v243 offset:384
    ds_read_b64_tr_b16 v[226:227], v243 offset:896
    v_max3_f32 v253, v253, v221, v222
    v_mfma_f32_16x16x32_bf16 v[76:79], v[228:231], v[200:203], v[76:79]
    v_max_f32 v253, v253, v223
    s_waitcnt lgkmcnt(4)
    v_mfma_f32_16x16x32_bf16 v[80:83], v[232:235], v[192:195], v[80:83]
    ds_read_b64_tr_b16 v[228:229], v243 offset:392
    ds_read_b64_tr_b16 v[230:231], v243 offset:904
    v_fma_f32 v254, v252, s42, v248
    v_mfma_f32_16x16x32_bf16 v[84:87], v[232:235], v[200:203], v[84:87]
    s_waitcnt lgkmcnt(4)
    v_mfma_f32_16x16x32_bf16 v[88:91], v[236:239], v[192:195], v[88:91]
    ds_read_b64_tr_b16 v[232:233], v243 offset:448
    ds_read_b64_tr_b16 v[234:235], v243 offset:960
    s_add_u32 s38, s47, 344064
    s_add_u32 m0, s55, 17408
    s_nop 0
    buffer_load_dwordx4 v247, s[24:27], s38 offen lds
    v_cmp_lt_f32 s[92:93], s44, v254
    v_mfma_f32_16x16x32_bf16 v[92:95], v[236:239], v[200:203], v[92:95]
    v_fma_f32 v254, v253, s42, v249
    s_waitcnt lgkmcnt(4)
    v_mfma_f32_16x16x32_bf16 v[96:99], v[224:227], v[192:195], v[96:99]
    ds_read_b64_tr_b16 v[236:237], v243 offset:456
    ds_read_b64_tr_b16 v[238:239], v243 offset:968
    v_cmp_lt_f32 vcc, s44, v254
    v_mfma_f32_16x16x32_bf16 v[100:103], v[224:227], v[200:203], v[100:103]
    s_waitcnt lgkmcnt(4)
    v_mfma_f32_16x16x32_bf16 v[104:107], v[228:231], v[192:195], v[104:107]
    s_add_u32 s35, s35, 34816
    s_cmp_ge_u32 s35, 139264
    s_cselect_b32 s40, 139264, 0
    s_sub_u32 s35, s35, s40
    v_add_u32 v242, s35, v240
    v_xor_b32 v244, 16, v242
    v_add_u32 v243, s35, v241
    ds_read_b64_tr_b16 v[224:225], v243 offset:0
    ds_read_b64_tr_b16 v[226:227], v243 offset:512
    v_mfma_f32_16x16x32_bf16 v[108:111], v[228:231], v[200:203], v[108:111]
    s_add_u32 s38, s47, 351232
    s_add_u32 m0, s55, 18432
    s_nop 0
    buffer_load_dwordx4 v246, s[24:27], s38 offen lds
    s_add_u32 s47, s47, 128
    s_waitcnt lgkmcnt(4)
    v_mfma_f32_16x16x32_bf16 v[112:115], v[232:235], v[192:195], v[112:115]
    ds_read_b64_tr_b16 v[228:229], v243 offset:8
    ds_read_b64_tr_b16 v[230:231], v243 offset:520
    v_mfma_f32_16x16x32_bf16 v[116:119], v[232:235], v[200:203], v[116:119]
    s_waitcnt lgkmcnt(4)
    v_mfma_f32_16x16x32_bf16 v[120:123], v[236:239], v[192:195], v[120:123]
    ds_read_b64_tr_b16 v[232:233], v243 offset:64
    ds_read_b64_tr_b16 v[234:235], v243 offset:576
    v_mfma_f32_16x16x32_bf16 v[124:127], v[236:239], v[200:203], v[124:127]
    s_or_b64 vcc, vcc, s[92:93]
    s_cbranch_scc1 L_rare_e
L_back_e:
    v_fma_f32 v208, v208, s42, v248
    v_fma_f32 v209, v209, s42, v248
    v_exp_f32 v208, v208
    v_exp_f32 v209, v209
    v_add_f32 v250, v250, v208
    v_add_f32 v250, v250, v209
    v_cvt_pk_bf16_f32 v208, v208, v209
    v_fma_f32 v210, v210, s42, v248
    v_fma_f32 v211, v211, s42, v248
    v_exp_f32 v210, v210
    v_exp_f32 v211, v211
    v_add_f32 v250, v250, v210
    v_add_f32 v250, v250, v211
    v_cvt_pk_bf16_f32 v209, v210, v211
    v_fma_f32 v212, v212, s42, v248
    v_fma_f32 v213, v213, s42, v248
    v_exp_f32 v212, v212
    v_exp_f32 v213, v213
    v_add_f32 v250, v250, v212
    v_add_f32 v250, v250, v213
    v_cvt_pk_bf16_f32 v210, v212, v213
    v_fma_f32 v214, v214, s42, v248
    v_fma_f32 v215, v215, s42, v248
    v_exp_f32 v214, v214
    v_exp_f32 v215, v215
    v_add_f32 v250, v250, v214
    v_add_f32 v250, v250, v215
    v_cvt_pk_bf16_f32 v211, v214, v215
    v_fma_f32 v216, v216, s42, v249
    v_fma_f32 v217, v217, s42, v249
    v_exp_f32 v216, v216
    v_exp_f32 v217, v217
    v_add_f32 v251, v251, v216
    v_add_f32 v251, v251, v217
    v_cvt_pk_bf16_f32 v216, v216, v217
    v_fma_f32 v218, v218, s42, v249
    v_fma_f32 v219, v219, s42, v249
    v_exp_f32 v218, v218
    v_exp_f32 v219, v219
    v_add_f32 v251, v251, v218
    v_add_f32 v251, v251, v219
    v_cvt_pk_bf16_f32 v217, v218, v219
    v_fma_f32 v220, v220, s42, v249
    v_fma_f32 v221, v221, s42, v249
    v_exp_f32 v220, v220
    v_exp_f32 v221, v221
    v_add_f32 v251, v251, v220
    v_add_f32 v251, v251, v221
    v_cvt_pk_bf16_f32 v218, v220, v221
    v_fma_f32 v222, v222, s42, v249
    v_fma_f32 v223, v223, s42, v249
    v_exp_f32 v222, v222
    v_exp_f32 v223, v223
    v_add_f32 v251, v251, v222
    v_add_f32 v251, v251, v223
    v_cvt_pk_bf16_f32 v219, v222, v223
    v_mov_b32 v254, v250
    s_nop 1
    v_permlane16_swap_b32 v250, v254
    v_add_f32 v250, v250, v254
    v_mov_b32 v254, v250
    s_nop 1
    v_permlane32_swap_b32 v250, v254
    v_add_f32 v250, v250, v254
    v_rcp_f32 v250, v250
    v_mov_b32 v254, v251
    s_nop 1
    v_permlane16_swap_b32 v251, v254
    v_add_f32 v251, v251, v254
    v_mov_b32 v254, v251
    s_nop 1
    v_permlane32_swap_b32 v251, v254
    v_add_f32 v251, v251, v254
    v_rcp_f32 v251, v251
    s_waitcnt lgkmcnt(4)
    v_mfma_f32_16x16x32_bf16 v[0:3], v[224:227], v[208:211], v[0:3]
    ds_read_b64_tr_b16 v[236:237], v243 offset:72
    ds_read_b64_tr_b16 v[238:239], v243 offset:584
    v_mfma_f32_16x16x32_bf16 v[4:7], v[224:227], v[216:219], v[4:7]
    s_waitcnt lgkmcnt(4)
    v_mfma_f32_16x16x32_bf16 v[8:11], v[228:231], v[208:211], v[8:11]
    ds_read_b64_tr_b16 v[224:225], v243 offset:128
    ds_read_b64_tr_b16 v[226:227], v243 offset:640
    v_mfma_f32_16x16x32_bf16 v[12:15], v[228:231], v[216:219], v[12:15]
    s_waitcnt lgkmcnt(4)
    v_mfma_f32_16x16x32_bf16 v[16:19], v[232:235], v[208:211], v[16:19]
    ds_read_b64_tr_b16 v[228:229], v243 offset:136
    ds_read_b64_tr_b16 v[230:231], v243 offset:648
    v_mfma_f32_16x16x32_bf16 v[20:23], v[232:235], v[216:219], v[20:23]
    s_waitcnt lgkmcnt(4)
    v_mfma_f32_16x16x32_bf16 v[24:27], v[236:239], v[208:211], v[24:27]
    ds_read_b64_tr_b16 v[232:233], v243 offset:192
    ds_read_b64_tr_b16 v[234:235], v243 offset:704
    v_mfma_f32_16x16x32_bf16 v[28:31], v[236:239], v[216:219], v[28:31]
    s_waitcnt vmcnt(4)
    s_barrier
    s_add_u32 s55, s36, s50
    s_add_u32 s36, s36, 34816
    s_cmp_ge_u32 s36, 139264
    s_cselect_b32 s40, 139264, 0
    s_sub_u32 s36, s36, s40
    v_mul_f32 v0, v0, v250
    v_mul_f32 v1, v1, v250
    v_mul_f32 v2, v2, v250
    v_mul_f32 v3, v3, v250
    v_cvt_pk_bf16_f32 v128, v0, v1
    v_cvt_pk_bf16_f32 v129, v2, v3
    s_waitcnt lgkmcnt(4)
    v_mfma_f32_16x16x32_bf16 v[32:35], v[224:227], v[208:211], v[32:35]
    ds_read_b64_tr_b16 v[236:237], v243 offset:200
    ds_read_b64_tr_b16 v[238:239], v243 offset:712
    v_mul_f32 v8, v8, v250
    v_mul_f32 v9, v9, v250
    v_mul_f32 v10, v10, v250
    v_mul_f32 v11, v11, v250
    v_cvt_pk_bf16_f32 v130, v8, v9
    v_cvt_pk_bf16_f32 v131, v10, v11
    v_mfma_f32_16x16x32_bf16 v[36:39], v[224:227], v[216:219], v[36:39]
    v_mul_f32 v4, v4, v251
    v_mul_f32 v5, v5, v251
    v_mul_f32 v6, v6, v251
    v_mul_f32 v7, v7, v251
    v_cvt_pk_bf16_f32 v160, v4, v5
    v_cvt_pk_bf16_f32 v161, v6, v7
    s_waitcnt lgkmcnt(4)
    v_mfma_f32_16x16x32_bf16 v[40:43], v[228:231], v[208:211], v[40:43]
    ds_read_b64_tr_b16 v[224:225], v243 offset:256
    ds_read_b64_tr_b16 v[226:227], v243 offset:768
    v_mul_f32 v12, v12, v251
    v_mul_f32 v13, v13, v251
    v_mul_f32 v14, v14, v251
    v_mul_f32 v15, v15, v251
    v_cvt_pk_bf16_f32 v162, v12, v13
    v_cvt_pk_bf16_f32 v163, v14, v15
    v_mfma_f32_16x16x32_bf16 v[44:47], v[228:231], v[216:219], v[44:47]
    v_mul_f32 v16, v16, v250
    v_mul_f32 v17, v17, v250
    v_mul_f32 v18, v18, v250
    v_mul_f32 v19, v19, v250
    v_cvt_pk_bf16_f32 v132, v16, v17
    v_cvt_pk_bf16_f32 v133, v18, v19
    s_waitcnt lgkmcnt(4)
    v_mfma_f32_16x16x32_bf16 v[48:51], v[232:235], v[208:211], v[48:51]
    ds_read_b64_tr_b16 v[228:229], v243 offset:264
    ds_read_b64_tr_b16 v[230:231], v243 offset:776
    s_add_u32 s38, s47, 0
    s_add_u32 m0, s55, 0
    s_nop 0
    buffer_load_dwordx4 v247, s[24:27], s38 offen lds
    v_mul_f32 v24, v24, v250
    v_mul_f32 v25, v25, v250
    v_mul_f32 v26, v26, v250
    v_mul_f32 v27, v27, v250
    v_cvt_pk_bf16_f32 v134, v24, v25
    v_cvt_pk_bf16_f32 v135, v26, v27
    v_mfma_f32_16x16x32_bf16 v[52:55], v[232:235], v[216:219], v[52:55]
    v_mul_f32 v20, v20, v251
    v_mul_f32 v21, v21, v251
    v_mul_f32 v22, v22, v251
    v_mul_f32 v23, v23, v251
    v_cvt_pk_bf16_f32 v164, v20, v21
    v_cvt_pk_bf16_f32 v165, v22, v23
    s_waitcnt lgkmcnt(4)
    v_mfma_f32_16x16x32_bf16 v[56:59], v[236:239], v[208:211], v[56:59]
    ds_read_b64_tr_b16 v[232:233], v243 offset:320
    ds_read_b64_tr_b16 v[234:235], v243 offset:832
    v_mul_f32 v28, v28, v251
    v_mul_f32 v29, v29, v251
    v_mul_f32 v30, v30, v251
    v_mul_f32 v31, v31, v251
    v_cvt_pk_bf16_f32 v166, v28, v29
    v_cvt_pk_bf16_f32 v167, v30, v31
    v_mfma_f32_16x16x32_bf16 v[60:63], v[236:239], v[216:219], v[60:63]
    v_mul_f32 v32, v32, v250
    v_mul_f32 v33, v33, v250
    v_mul_f32 v34, v34, v250
    v_mul_f32 v35, v35, v250
    v_cvt_pk_bf16_f32 v136, v32, v33
    v_cvt_pk_bf16_f32 v137, v34, v35
    s_waitcnt lgkmcnt(4)
    v_mfma_f32_16x16x32_bf16 v[64:67], v[224:227], v[208:211], v[64:67]
    ds_read_b64_tr_b16 v[236:237], v243 offset:328
    ds_read_b64_tr_b16 v[238:239], v243 offset:840
    v_mul_f32 v40, v40, v250
    v_mul_f32 v41, v41, v250
    v_mul_f32 v42, v42, v250
    v_mul_f32 v43, v43, v250
    v_cvt_pk_bf16_f32 v138, v40, v41
    v_cvt_pk_bf16_f32 v139, v42, v43
    v_mfma_f32_16x16x32_bf16 v[68:71], v[224:227], v[216:219], v[68:71]
    s_add_u32 s38, s47, 7168
    s_add_u32 m0, s55, 1024
    s_nop 0
    buffer_load_dwordx4 v246, s[24:27], s38 offen lds
    v_mul_f32 v36, v36, v251
    v_mul_f32 v37, v37, v251
    v_mul_f32 v38, v38, v251
    v_mul_f32 v39, v39, v251
    v_cvt_pk_bf16_f32 v168, v36, v37
    v_cvt_pk_bf16_f32 v169, v38, v39
    s_waitcnt lgkmcnt(4)
    v_mfma_f32_16x16x32_bf16 v[72:75], v[228:231], v[208:211], v[72:75]
    ds_read_b64_tr_b16 v[224:225], v243 offset:384
    ds_read_b64_tr_b16 v[226:227], v243 offset:896
    v_mul_f32 v44, v44, v251
    v_mul_f32 v45, v45, v251
    v_mul_f32 v46, v46, v251
    v_mul_f32 v47, v47, v251
    v_cvt_pk_bf16_f32 v170, v44, v45
    v_cvt_pk_bf16_f32 v171, v46, v47
    v_mfma_f32_16x16x32_bf16 v[76:79], v[228:231], v[216:219], v[76:79]
    v_mul_f32 v48, v48, v250
    v_mul_f32 v49, v49, v250
    v_mul_f32 v50, v50, v250
    v_mul_f32 v51, v51, v250
    v_cvt_pk_bf16_f32 v140, v48, v49
    v_cvt_pk_bf16_f32 v141, v50, v51
    s_waitcnt lgkmcnt(4)
    v_mfma_f32_16x16x32_bf16 v[80:83], v[232:235], v[208:211], v[80:83]
    ds_read_b64_tr_b16 v[228:229], v243 offset:392
    ds_read_b64_tr_b16 v[230:231], v243 offset:904
    v_mul_f32 v56, v56, v250
    v_mul_f32 v57, v57, v250
    v_mul_f32 v58, v58, v250
    v_mul_f32 v59, v59, v250
    v_cvt_pk_bf16_f32 v142, v56, v57
    v_cvt_pk_bf16_f32 v143, v58, v59
    v_mfma_f32_16x16x32_bf16 v[84:87], v[232:235], v[216:219], v[84:87]
    v_mul_f32 v52, v52, v251
    v_mul_f32 v53, v53, v251
    v_mul_f32 v54, v54, v251
    v_mul_f32 v55, v55, v251
    v_cvt_pk_bf16_f32 v172, v52, v53
    v_cvt_pk_bf16_f32 v173, v54, v55
    s_waitcnt lgkmcnt(4)
    v_mfma_f32_16x16x32_bf16 v[88:91], v[236:239], v[208:211], v[88:91]
    ds_read_b64_tr_b16 v[232:233], v243 offset:448
    ds_read_b64_tr_b16 v[234:235], v243 offset:960
    s_add_u32 s38, s47, 229376
    s_add_u32 m0, s55, 17408
    s_nop 0
    buffer_load_dwordx4 v247, s[24:27], s38 offen lds
    v_mul_f32 v60, v60, v251
    v_mul_f32 v61, v61, v251
    v_mul_f32 v62, v62, v251
    v_mul_f32 v63, v63, v251
    v_cvt_pk_bf16_f32 v174, v60, v61
    v_cvt_pk_bf16_f32 v175, v62, v63
    v_mfma_f32_16x16x32_bf16 v[92:95], v[236:239], v[216:219], v[92:95]
    v_mul_f32 v64, v64, v250
    v_mul_f32 v65, v65, v250
    v_mul_f32 v66, v66, v250
    v_mul_f32 v67, v67, v250
    v_cvt_pk_bf16_f32 v144, v64, v65
    v_cvt_pk_bf16_f32 v145, v66, v67
    s_waitcnt lgkmcnt(4)
    v_mfma_f32_16x16x32_bf16 v[96:99], v[224:227], v[208:211], v[96:99]
    ds_read_b64_tr_b16 v[236:237], v243 offset:456
    ds_read_b64_tr_b16 v[238:239], v243 offset:968
    v_mul_f32 v72, v72, v250
    v_mul_f32 v73, v73, v250
    v_mul_f32 v74, v74, v250
    v_mul_f32 v75, v75, v250
    v_cvt_pk_bf16_f32 v146, v72, v73
    v_cvt_pk_bf16_f32 v147, v74, v75
    v_mfma_f32_16x16x32_bf16 v[100:103], v[224:227], v[216:219], v[100:103]
    v_mul_f32 v68, v68, v251
    v_mul_f32 v69, v69, v251
    v_mul_f32 v70, v70, v251
    v_mul_f32 v71, v71, v251
    v_cvt_pk_bf16_f32 v176, v68, v69
    v_cvt_pk_bf16_f32 v177, v70, v71
    s_waitcnt lgkmcnt(4)
    v_mfma_f32_16x16x32_bf16 v[104:107], v[228:231], v[208:211], v[104:107]
    v_lshrrev_b32 v252, 4, v255
    v_bfe_u32 v253, v255, 2, 2
    v_lshl_add_u32 v252, v252, 3, v253
    v_lshlrev_b32 v252, 7, v252
    v_bfe_u32 v253, v255, 3, 2
    s_lshl_b32 s40, s33, 1
    v_xor_b32 v253, s40, v253
    v_lshl_add_u32 v252, v253, 5, v252
    v_and_b32 v253, 3, v255
    v_lshl_add_u32 v252, v253, 3, v252
    s_mul_i32 s40, s33, 17408
    v_add_u32 v240, s40, v252
    s_add_u32 s35, s35, 34816
    s_cmp_ge_u32 s35, 139264
    s_cselect_b32 s40, 139264, 0
    s_sub_u32 s35, s35, s40
    v_add_u32 v242, s35, v240
    v_xor_b32 v243, 32, v242
    v_xor_b32 v244, 64, v242
    v_xor_b32 v241, 96, v242
    ds_read_b64_tr_b16 v[224:225], v244 offset:0
    ds_read_b64_tr_b16 v[226:227], v244 offset:512
    v_mul_f32 v76, v76, v251
    v_mul_f32 v77, v77, v251
    v_mul_f32 v78, v78, v251
    v_mul_f32 v79, v79, v251
    v_cvt_pk_bf16_f32 v178, v76, v77
    v_cvt_pk_bf16_f32 v179, v78, v79
    v_mfma_f32_16x16x32_bf16 v[108:111], v[228:231], v[216:219], v[108:111]
    s_add_u32 s38, s47, 236544
    s_add_u32 m0, s55, 18432
    s_nop 0
    buffer_load_dwordx4 v246, s[24:27], s38 offen lds
    v_mul_f32 v80, v80, v250
    v_mul_f32 v81, v81, v250
    v_mul_f32 v82, v82, v250
    v_mul_f32 v83, v83, v250
    v_cvt_pk_bf16_f32 v148, v80, v81
    v_cvt_pk_bf16_f32 v149, v82, v83
    s_waitcnt lgkmcnt(4)
    v_mfma_f32_16x16x32_bf16 v[112:115], v[232:235], v[208:211], v[112:115]
    ds_read_b64_tr_b16 v[228:229], v241 offset:0
    ds_read_b64_tr_b16 v[230:231], v241 offset:512
    v_mul_f32 v88, v88, v250
    v_mul_f32 v89, v89, v250
    v_mul_f32 v90, v90, v250
    v_mul_f32 v91, v91, v250
    v_cvt_pk_bf16_f32 v150, v88, v89
    v_cvt_pk_bf16_f32 v151, v90, v91
    v_mfma_f32_16x16x32_bf16 v[116:119], v[232:235], v[216:219], v[116:119]
    v_mul_f32 v84, v84, v251
    v_mul_f32 v85, v85, v251
    v_mul_f32 v86, v86, v251
    v_mul_f32 v87, v87, v251
    v_cvt_pk_bf16_f32 v180, v84, v85
    v_cvt_pk_bf16_f32 v181, v86, v87
    s_waitcnt lgkmcnt(4)
    v_mfma_f32_16x16x32_bf16 v[120:123], v[236:239], v[208:211], v[120:123]
    ds_read_b64_tr_b16 v[232:233], v242 offset:0
    ds_read_b64_tr_b16 v[234:235], v242 offset:512
    v_mul_f32 v92, v92, v251
    v_mul_f32 v93, v93, v251
    v_mul_f32 v94, v94, v251
    v_mul_f32 v95, v95, v251
    v_cvt_pk_bf16_f32 v182, v92, v93
    v_cvt_pk_bf16_f32 v183, v94, v95
    v_mfma_f32_16x16x32_bf16 v[124:127], v[236:239], v[216:219], v[124:127]
    v_mul_f32 v96, v96, v250
    v_mul_f32 v97, v97, v250
    v_mul_f32 v98, v98, v250
    v_mul_f32 v99, v99, v250
    v_cvt_pk_bf16_f32 v152, v96, v97
    v_cvt_pk_bf16_f32 v153, v98, v99
    s_lshl_b32 s37, s32, 12
    s_add_u32 s37, s37, 139264
    s_sub_u32 s38, s32, 6
    s_mul_i32 s38, s38, 69632
    s_add_u32 s38, s38, 16384
    s_cmp_ge_u32 s32, 6
    s_cselect_b32 s37, s38, s37
    s_mov_b32 s38, 1024
    s_cselect_b32 s38, 17408, s38
    v_add_u32 v56, s37, v245
    s_add_u32 s37, s37, s38
    v_add_u32 v57, s37, v245
    s_add_u32 s37, s37, s38
    v_add_u32 v58, s37, v245
    s_add_u32 s37, s37, s38
    v_add_u32 v59, s37, v245
    s_xor_b32 s53, s32, 4
    s_lshl_b32 s37, s53, 12
    s_add_u32 s37, s37, 139264
    s_sub_u32 s38, s53, 6
    s_mul_i32 s38, s38, 69632
    s_add_u32 s38, s38, 16384
    s_cmp_ge_u32 s53, 6
    s_cselect_b32 s37, s38, s37
    s_mov_b32 s38, 1024
    s_cselect_b32 s38, 17408, s38
    v_add_u32 v60, s37, v245
    s_add_u32 s37, s37, s38
    v_add_u32 v61, s37, v245
    s_add_u32 s37, s37, s38
    v_add_u32 v62, s37, v245
    s_add_u32 s37, s37, s38
    v_add_u32 v63, s37, v245
    s_mul_i32 s51, s32, 14336
    s_waitcnt lgkmcnt(4)
    v_mfma_f32_16x16x32_bf16 v[208:211], v[224:227], v[128:131], 0
    ds_read_b64_tr_b16 v[236:237], v243 offset:0
    ds_read_b64_tr_b16 v[238:239], v243 offset:512
    v_mfma_f32_16x16x32_bf16 v[212:215], v[224:227], v[160:163], 0
    s_waitcnt lgkmcnt(4)
    v_mfma_f32_16x16x32_bf16 v[216:219], v[228:231], v[128:131], 0
    ds_read_b64_tr_b16 v[224:225], v244 offset:4096
    ds_read_b64_tr_b16 v[226:227], v244 offset:4608
    v_mul_f32 v104, v104, v250
    v_mul_f32 v105, v105, v250
    v_mul_f32 v106, v106, v250
    v_mul_f32 v107, v107, v250
    v_cvt_pk_bf16_f32 v154, v104, v105
    v_cvt_pk_bf16_f32 v155, v106, v107
    v_mfma_f32_16x16x32_bf16 v[220:223], v[228:231], v[160:163], 0
    v_mul_f32 v100, v100, v251
    v_mul_f32 v101, v101, v251
    v_mul_f32 v102, v102, v251
    v_mul_f32 v103, v103, v251
    v_cvt_pk_bf16_f32 v184, v100, v101
    v_cvt_pk_bf16_f32 v185, v102, v103
    s_waitcnt lgkmcnt(4)
    v_mfma_f32_16x16x32_bf16 v[192:195], v[232:235], v[128:131], 0
    ds_read_b64_tr_b16 v[228:229], v241 offset:4096
    ds_read_b64_tr_b16 v[230:231], v241 offset:4608
    v_mul_f32 v108, v108, v251
    v_mul_f32 v109, v109, v251
    v_mul_f32 v110, v110, v251
    v_mul_f32 v111, v111, v251
    v_cvt_pk_bf16_f32 v186, v108, v109
    v_cvt_pk_bf16_f32 v187, v110, v111
    v_mfma_f32_16x16x32_bf16 v[196:199], v[232:235], v[160:163], 0
    v_mul_f32 v112, v112, v250
    v_mul_f32 v113, v113, v250
    v_mul_f32 v114, v114, v250
    v_mul_f32 v115, v115, v250
    v_cvt_pk_bf16_f32 v156, v112, v113
    v_cvt_pk_bf16_f32 v157, v114, v115
    s_waitcnt lgkmcnt(4)
    v_mfma_f32_16x16x32_bf16 v[200:203], v[236:239], v[128:131], 0
    ds_read_b64_tr_b16 v[232:233], v242 offset:4096
    ds_read_b64_tr_b16 v[234:235], v242 offset:4608
    v_mul_f32 v120, v120, v250
    v_mul_f32 v121, v121, v250
    v_mul_f32 v122, v122, v250
    v_mul_f32 v123, v123, v250
    v_cvt_pk_bf16_f32 v158, v120, v121
    v_cvt_pk_bf16_f32 v159, v122, v123
    v_mfma_f32_16x16x32_bf16 v[204:207], v[236:239], v[160:163], 0
    v_mul_f32 v116, v116, v251
    v_mul_f32 v117, v117, v251
    v_mul_f32 v118, v118, v251
    v_mul_f32 v119, v119, v251
    v_cvt_pk_bf16_f32 v188, v116, v117
    v_cvt_pk_bf16_f32 v189, v118, v119
    s_waitcnt lgkmcnt(4)
    v_mfma_f32_16x16x32_bf16 v[208:211], v[224:227], v[132:135], v[208:211]
    ds_read_b64_tr_b16 v[236:237], v243 offset:4096
    ds_read_b64_tr_b16 v[238:239], v243 offset:4608
    v_mul_f32 v124, v124, v251
    v_mul_f32 v125, v125, v251
    v_mul_f32 v126, v126, v251
    v_mul_f32 v127, v127, v251
    v_cvt_pk_bf16_f32 v190, v124, v125
    v_cvt_pk_bf16_f32 v191, v126, v127
    v_mfma_f32_16x16x32_bf16 v[212:215], v[224:227], v[164:167], v[212:215]
    s_waitcnt lgkmcnt(4)
    v_mfma_f32_16x16x32_bf16 v[216:219], v[228:231], v[132:135], v[216:219]
    ds_read_b64_tr_b16 v[224:225], v244 offset:8192
    ds_read_b64_tr_b16 v[226:227], v244 offset:8704
    v_mfma_f32_16x16x32_bf16 v[220:223], v[228:231], v[164:167], v[220:223]
    s_waitcnt vmcnt(4)
    s_barrier
    s_add_u32 s55, s36, s50
    s_add_u32 s36, s36, 34816
    s_cmp_ge_u32 s36, 139264
    s_cselect_b32 s40, 139264, 0
    s_sub_u32 s36, s36, s40
    s_waitcnt lgkmcnt(4)
    v_mfma_f32_16x16x32_bf16 v[192:195], v[232:235], v[132:135], v[192:195]
    ds_read_b64_tr_b16 v[228:229], v241 offset:8192
    ds_read_b64_tr_b16 v[230:231], v241 offset:8704
    v_mfma_f32_16x16x32_bf16 v[196:199], v[232:235], v[164:167], v[196:199]
    s_waitcnt lgkmcnt(4)
    v_mfma_f32_16x16x32_bf16 v[200:203], v[236:239], v[132:135], v[200:203]
    ds_read_b64_tr_b16 v[232:233], v242 offset:8192
    ds_read_b64_tr_b16 v[234:235], v242 offset:8704
    v_mfma_f32_16x16x32_bf16 v[204:207], v[236:239], v[164:167], v[204:207]
    s_add_u32 s38, s47, 114688
    s_add_u32 m0, s55, 0
    s_nop 0
    buffer_load_dwordx4 v247, s[24:27], s38 offen lds
    s_waitcnt lgkmcnt(4)
    v_mfma_f32_16x16x32_bf16 v[208:211], v[224:227], v[136:139], v[208:211]
    ds_read_b64_tr_b16 v[236:237], v243 offset:8192
    ds_read_b64_tr_b16 v[238:239], v243 offset:8704
    v_mfma_f32_16x16x32_bf16 v[212:215], v[224:227], v[168:171], v[212:215]
    s_waitcnt lgkmcnt(4)
    v_mfma_f32_16x16x32_bf16 v[216:219], v[228:231], v[136:139], v[216:219]
    ds_read_b64_tr_b16 v[224:225], v244 offset:12288
    ds_read_b64_tr_b16 v[226:227], v244 offset:12800
    v_mfma_f32_16x16x32_bf16 v[220:223], v[228:231], v[168:171], v[220:223]
    s_add_u32 s38, s47, 121856
    s_add_u32 m0, s55, 1024
    s_nop 0
    buffer_load_dwordx4 v246, s[24:27], s38 offen lds
    s_waitcnt lgkmcnt(4)
    v_mfma_f32_16x16x32_bf16 v[192:195], v[232:235], v[136:139], v[192:195]
    ds_read_b64_tr_b16 v[228:229], v241 offset:12288
    ds_read_b64_tr_b16 v[230:231], v241 offset:12800
    v_mfma_f32_16x16x32_bf16 v[196:199], v[232:235], v[168:171], v[196:199]
    s_waitcnt lgkmcnt(4)
    v_mfma_f32_16x16x32_bf16 v[200:203], v[236:239], v[136:139], v[200:203]
    ds_read_b64_tr_b16 v[232:233], v242 offset:12288
    ds_read_b64_tr_b16 v[234:235], v242 offset:12800
    v_mfma_f32_16x16x32_bf16 v[204:207], v[236:239], v[168:171], v[204:207]
    s_add_u32 s38, s47, 344064
    s_add_u32 m0, s55, 17408
    s_nop 0
    buffer_load_dwordx4 v247, s[24:27], s38 offen lds
    s_waitcnt lgkmcnt(4)
    v_mfma_f32_16x16x32_bf16 v[208:211], v[224:227], v[140:143], v[208:211]
    ds_read_b64_tr_b16 v[236:237], v243 offset:12288
    ds_read_b64_tr_b16 v[238:239], v243 offset:12800
    v_mfma_f32_16x16x32_bf16 v[212:215], v[224:227], v[172:175], v[212:215]
    s_waitcnt lgkmcnt(4)
    v_mfma_f32_16x16x32_bf16 v[216:219], v[228:231], v[140:143], v[216:219]
    s_add_u32 s35, s35, 34816
    s_cmp_ge_u32 s35, 139264
    s_cselect_b32 s40, 139264, 0
    s_sub_u32 s35, s35, s40
    v_add_u32 v242, s35, v240
    v_xor_b32 v243, 32, v242
    v_xor_b32 v244, 64, v242
    v_xor_b32 v241, 96, v242
    ds_read_b64_tr_b16 v[224:225], v244 offset:0
    ds_read_b64_tr_b16 v[226:227], v244 offset:512
    v_mfma_f32_16x16x32_bf16 v[220:223], v[228:231], v[172:175], v[220:223]
    s_add_u32 s38, s47, 351232
    s_add_u32 m0, s55, 18432
    s_nop 0
    buffer_load_dwordx4 v246, s[24:27], s38 offen lds
    s_add_u32 s47, s47, 128
    s_waitcnt lgkmcnt(4)
    v_mfma_f32_16x16x32_bf16 v[192:195], v[232:235], v[140:143], v[192:195]
    ds_read_b64_tr_b16 v[228:229], v241 offset:0
    ds_read_b64_tr_b16 v[230:231], v241 offset:512
    v_mfma_f32_16x16x32_bf16 v[196:199], v[232:235], v[172:175], v[196:199]
    s_waitcnt lgkmcnt(4)
    v_mfma_f32_16x16x32_bf16 v[200:203], v[236:239], v[140:143], v[200:203]
    ds_read_b64_tr_b16 v[232:233], v242 offset:0
    ds_read_b64_tr_b16 v[234:235], v242 offset:512
    v_mfma_f32_16x16x32_bf16 v[204:207], v[236:239], v[172:175], v[204:207]
    s_waitcnt lgkmcnt(4)
    v_mfma_f32_16x16x32_bf16 v[208:211], v[224:227], v[144:147], v[208:211]
    ds_read_b64_tr_b16 v[236:237], v243 offset:0
    ds_read_b64_tr_b16 v[238:239], v243 offset:512
    v_mfma_f32_16x16x32_bf16 v[212:215], v[224:227], v[176:179], v[212:215]
    s_waitcnt lgkmcnt(4)
    v_mfma_f32_16x16x32_bf16 v[216:219], v[228:231], v[144:147], v[216:219]
    ds_read_b64_tr_b16 v[224:225], v244 offset:4096
    ds_read_b64_tr_b16 v[226:227], v244 offset:4608
    v_mfma_f32_16x16x32_bf16 v[220:223], v[228:231], v[176:179], v[220:223]
    s_waitcnt lgkmcnt(4)
    v_mfma_f32_16x16x32_bf16 v[192:195], v[232:235], v[144:147], v[192:195]
    ds_read_b64_tr_b16 v[228:229], v241 offset:4096
    ds_read_b64_tr_b16 v[230:231], v241 offset:4608
    v_mfma_f32_16x16x32_bf16 v[196:199], v[232:235], v[176:179], v[196:199]
    s_waitcnt lgkmcnt(4)
    v_mfma_f32_16x16x32_bf16 v[200:203], v[236:239], v[144:147], v[200:203]
    ds_read_b64_tr_b16 v[232:233], v242 offset:4096
    ds_read_b64_tr_b16 v[234:235], v242 offset:4608
    v_mfma_f32_16x16x32_bf16 v[204:207], v[236:239], v[176:179], v[204:207]
    s_waitcnt lgkmcnt(4)
    v_mfma_f32_16x16x32_bf16 v[208:211], v[224:227], v[148:151], v[208:211]
    ds_read_b64_tr_b16 v[236:237], v243 offset:4096
    ds_read_b64_tr_b16 v[238:239], v243 offset:4608
    v_mfma_f32_16x16x32_bf16 v[212:215], v[224:227], v[180:183], v[212:215]
    s_waitcnt lgkmcnt(4)
    v_mfma_f32_16x16x32_bf16 v[216:219], v[228:231], v[148:151], v[216:219]
    ds_read_b64_tr_b16 v[224:225], v244 offset:8192
    ds_read_b64_tr_b16 v[226:227], v244 offset:8704
    v_mfma_f32_16x16x32_bf16 v[220:223], v[228:231], v[180:183], v[220:223]
    s_waitcnt vmcnt(4)
    s_barrier
    s_add_u32 s55, s36, s50
    s_add_u32 s36, s36, 34816
    s_cmp_ge_u32 s36, 139264
    s_cselect_b32 s40, 139264, 0
    s_sub_u32 s36, s36, s40
    s_waitcnt lgkmcnt(4)
    v_mfma_f32_16x16x32_bf16 v[192:195], v[232:235], v[148:151], v[192:195]
    ds_read_b64_tr_b16 v[228:229], v241 offset:8192
    ds_read_b64_tr_b16 v[230:231], v241 offset:8704
    v_mfma_f32_16x16x32_bf16 v[196:199], v[232:235], v[180:183], v[196:199]
    s_waitcnt lgkmcnt(4)
    v_mfma_f32_16x16x32_bf16 v[200:203], v[236:239], v[148:151], v[200:203]
    ds_read_b64_tr_b16 v[232:233], v242 offset:8192
    ds_read_b64_tr_b16 v[234:235], v242 offset:8704
    v_mfma_f32_16x16x32_bf16 v[204:207], v[236:239], v[180:183], v[204:207]
    s_add_u32 s38, s47, 0
    s_add_u32 m0, s55, 0
    s_nop 0
    buffer_load_dwordx4 v247, s[24:27], s38 offen lds
    s_waitcnt lgkmcnt(4)
    v_mfma_f32_16x16x32_bf16 v[208:211], v[224:227], v[152:155], v[208:211]
    ds_read_b64_tr_b16 v[236:237], v243 offset:8192
    ds_read_b64_tr_b16 v[238:239], v243 offset:8704
    v_mfma_f32_16x16x32_bf16 v[212:215], v[224:227], v[184:187], v[212:215]
    s_waitcnt lgkmcnt(4)
    v_mfma_f32_16x16x32_bf16 v[216:219], v[228:231], v[152:155], v[216:219]
    ds_read_b64_tr_b16 v[224:225], v244 offset:12288
    ds_read_b64_tr_b16 v[226:227], v244 offset:12800
    v_mfma_f32_16x16x32_bf16 v[220:223], v[228:231], v[184:187], v[220:223]
    s_add_u32 s38, s47, 7168
    s_add_u32 m0, s55, 1024
    s_nop 0
    buffer_load_dwordx4 v246, s[24:27], s38 offen lds
    s_waitcnt lgkmcnt(4)
    v_mfma_f32_16x16x32_bf16 v[192:195], v[232:235], v[152:155], v[192:195]
    ds_read_b64_tr_b16 v[228:229], v241 offset:12288
    ds_read_b64_tr_b16 v[230:231], v241 offset:12800
    v_mfma_f32_16x16x32_bf16 v[196:199], v[232:235], v[184:187], v[196:199]
    s_waitcnt lgkmcnt(4)
    v_mfma_f32_16x16x32_bf16 v[200:203], v[236:239], v[152:155], v[200:203]
    ds_read_b64_tr_b16 v[232:233], v242 offset:12288
    ds_read_b64_tr_b16 v[234:235], v242 offset:12800
    v_mfma_f32_16x16x32_bf16 v[204:207], v[236:239], v[184:187], v[204:207]
    s_add_u32 s38, s47, 229376
    s_add_u32 m0, s55, 17408
    s_nop 0
    buffer_load_dwordx4 v247, s[24:27], s38 offen lds
    s_waitcnt lgkmcnt(4)
    v_mfma_f32_16x16x32_bf16 v[208:211], v[224:227], v[156:159], v[208:211]
    ds_read_b64_tr_b16 v[236:237], v243 offset:12288
    ds_read_b64_tr_b16 v[238:239], v243 offset:12800
    v_mfma_f32_16x16x32_bf16 v[212:215], v[224:227], v[188:191], v[212:215]
    s_waitcnt lgkmcnt(4)
    v_mfma_f32_16x16x32_bf16 v[216:219], v[228:231], v[156:159], v[216:219]
    s_add_u32 s35, s35, 34816
    s_cmp_ge_u32 s35, 139264
    s_cselect_b32 s40, 139264, 0
    s_sub_u32 s35, s35, s40
    v_add_u32 v242, s35, v240
    v_xor_b32 v243, 32, v242
    v_xor_b32 v244, 64, v242
    v_xor_b32 v241, 96, v242
    ds_read_b64_tr_b16 v[224:225], v244 offset:0
    ds_read_b64_tr_b16 v[226:227], v244 offset:512
    v_mfma_f32_16x16x32_bf16 v[220:223], v[228:231], v[188:191], v[220:223]
    s_add_u32 s38, s47, 236544
    s_add_u32 m0, s55, 18432
    s_nop 0
    buffer_load_dwordx4 v246, s[24:27], s38 offen lds
    s_waitcnt lgkmcnt(4)
    v_mfma_f32_16x16x32_bf16 v[192:195], v[232:235], v[156:159], v[192:195]
    ds_read_b64_tr_b16 v[228:229], v241 offset:0
    ds_read_b64_tr_b16 v[230:231], v241 offset:512
    v_mfma_f32_16x16x32_bf16 v[196:199], v[232:235], v[188:191], v[196:199]
    s_waitcnt lgkmcnt(4)
    v_mfma_f32_16x16x32_bf16 v[200:203], v[236:239], v[156:159], v[200:203]
    ds_read_b64_tr_b16 v[232:233], v242 offset:0
    ds_read_b64_tr_b16 v[234:235], v242 offset:512
    v_mfma_f32_16x16x32_bf16 v[204:207], v[236:239], v[188:191], v[204:207]
    s_mov_b32 s41, 2
L_p3:
    s_waitcnt lgkmcnt(4)
    v_mfma_f32_16x16x32_bf16 v[16:19], v[224:227], v[128:131], 0
    ds_read_b64_tr_b16 v[236:237], v243 offset:0
    ds_read_b64_tr_b16 v[238:239], v243 offset:512
    v_mfma_f32_16x16x32_bf16 v[20:23], v[224:227], v[160:163], 0
    s_waitcnt lgkmcnt(4)
    v_mfma_f32_16x16x32_bf16 v[24:27], v[228:231], v[128:131], 0
    ds_read_b64_tr_b16 v[224:225], v244 offset:4096
    ds_read_b64_tr_b16 v[226:227], v244 offset:4608
    ds_write_b128 v56, v[208:211]
    ds_write_b128 v57, v[212:215]
    ds_write_b128 v58, v[216:219]
    v_mfma_f32_16x16x32_bf16 v[28:31], v[228:231], v[160:163], 0
    ds_write_b128 v59, v[220:223]
    s_waitcnt lgkmcnt(8)
    v_mfma_f32_16x16x32_bf16 v[0:3], v[232:235], v[128:131], 0
    ds_read_b64_tr_b16 v[228:229], v241 offset:4096
    ds_read_b64_tr_b16 v[230:231], v241 offset:4608
    v_mfma_f32_16x16x32_bf16 v[4:7], v[232:235], v[160:163], 0
    s_waitcnt lgkmcnt(8)
    v_mfma_f32_16x16x32_bf16 v[8:11], v[236:239], v[128:131], 0
    ds_read_b64_tr_b16 v[232:233], v242 offset:4096
    ds_read_b64_tr_b16 v[234:235], v242 offset:4608
    v_mfma_f32_16x16x32_bf16 v[12:15], v[236:239], v[160:163], 0
    s_waitcnt lgkmcnt(8)
    v_mfma_f32_16x16x32_bf16 v[16:19], v[224:227], v[132:135], v[16:19]
    ds_read_b64_tr_b16 v[236:237], v243 offset:4096
    ds_read_b64_tr_b16 v[238:239], v243 offset:4608
    v_mfma_f32_16x16x32_bf16 v[20:23], v[224:227], v[164:167], v[20:23]
    s_waitcnt lgkmcnt(4)
    v_mfma_f32_16x16x32_bf16 v[24:27], v[228:231], v[132:135], v[24:27]
    ds_read_b64_tr_b16 v[224:225], v244 offset:8192
    ds_read_b64_tr_b16 v[226:227], v244 offset:8704
    v_mfma_f32_16x16x32_bf16 v[28:31], v[228:231], v[164:167], v[28:31]
    s_waitcnt vmcnt(4)
    s_barrier
    s_add_u32 s55, s36, s50
    s_add_u32 s36, s36, 34816
    s_cmp_ge_u32 s36, 139264
    s_cselect_b32 s40, 139264, 0
    s_sub_u32 s36, s36, s40
    s_waitcnt lgkmcnt(4)
    v_mfma_f32_16x16x32_bf16 v[0:3], v[232:235], v[132:135], v[0:3]
    ds_read_b64_tr_b16 v[228:229], v241 offset:8192
    ds_read_b64_tr_b16 v[230:231], v241 offset:8704
    ds_read_b128 v[32:35], v60
    ds_read_b128 v[36:39], v61
    ds_read_b128 v[40:43], v62
    v_mfma_f32_16x16x32_bf16 v[4:7], v[232:235], v[164:167], v[4:7]
    ds_read_b128 v[44:47], v63
    s_waitcnt lgkmcnt(8)
    v_mfma_f32_16x16x32_bf16 v[8:11], v[236:239], v[132:135], v[8:11]
    ds_read_b64_tr_b16 v[232:233], v242 offset:8192
    ds_read_b64_tr_b16 v[234:235], v242 offset:8704
    v_mfma_f32_16x16x32_bf16 v[12:15], v[236:239], v[164:167], v[12:15]
    s_add_u32 s38, s47, 114688
    s_add_u32 m0, s55, 0
    s_nop 0
    buffer_load_dwordx4 v247, s[24:27], s38 offen lds
    s_waitcnt lgkmcnt(2)
    v_add_f32 v32, v32, v192
    v_mfma_f32_16x16x32_bf16 v[16:19], v[224:227], v[136:139], v[16:19]
    ds_read_b64_tr_b16 v[236:237], v243 offset:8192
    ds_read_b64_tr_b16 v[238:239], v243 offset:8704
    v_add_f32 v33, v33, v193
    v_add_f32 v34, v34, v194
    v_add_f32 v35, v35, v195
    v_mfma_f32_16x16x32_bf16 v[20:23], v[224:227], v[168:171], v[20:23]
    v_add_f32 v36, v36, v196
    v_add_f32 v37, v37, v197
    v_add_f32 v38, v38, v198
    v_mfma_f32_16x16x32_bf16 v[24:27], v[228:231], v[136:139], v[24:27]
    ds_read_b64_tr_b16 v[224:225], v244 offset:12288
    ds_read_b64_tr_b16 v[226:227], v244 offset:12800
    v_add_f32 v39, v39, v199
    v_add_f32 v40, v40, v200
    v_add_f32 v41, v41, v201
    v_mfma_f32_16x16x32_bf16 v[28:31], v[228:231], v[168:171], v[28:31]
    s_add_u32 s38, s47, 121856
    s_add_u32 m0, s55, 1024
    s_nop 0
    buffer_load_dwordx4 v246, s[24:27], s38 offen lds
    v_add_f32 v42, v42, v202
    v_add_f32 v43, v43, v203
    v_add_f32 v44, v44, v204
    s_waitcnt lgkmcnt(4)
    v_mfma_f32_16x16x32_bf16 v[0:3], v[232:235], v[136:139], v[0:3]
    ds_read_b64_tr_b16 v[228:229], v241 offset:12288
    ds_read_b64_tr_b16 v[230:231], v241 offset:12800
    v_add_f32 v45, v45, v205
    v_add_f32 v46, v46, v206
    v_add_f32 v47, v47, v207
    v_mfma_f32_16x16x32_bf16 v[4:7], v[232:235], v[168:171], v[4:7]
    v_cvt_pk_bf16_f32 v48, v32, v33
    v_cvt_pk_bf16_f32 v49, v34, v35
    v_cvt_pk_bf16_f32 v52, v36, v37
    s_waitcnt lgkmcnt(4)
    v_mfma_f32_16x16x32_bf16 v[8:11], v[236:239], v[136:139], v[8:11]
    ds_read_b64_tr_b16 v[232:233], v242 offset:12288
    ds_read_b64_tr_b16 v[234:235], v242 offset:12800
    v_cvt_pk_bf16_f32 v53, v38, v39
    v_cvt_pk_bf16_f32 v50, v40, v41
    v_cvt_pk_bf16_f32 v51, v42, v43
    v_mfma_f32_16x16x32_bf16 v[12:15], v[236:239], v[168:171], v[12:15]
    s_add_u32 s38, s47, 344064
    s_add_u32 m0, s55, 17408
    s_nop 0
    buffer_load_dwordx4 v247, s[24:27], s38 offen lds
    v_cvt_pk_bf16_f32 v54, v44, v45
    v_cvt_pk_bf16_f32 v55, v46, v47
    buffer_store_dwordx4 v[48:51], v245, s[28:31], s51 offen offset:0 sc1
    buffer_store_dwordx4 v[52:55], v245, s[28:31], s51 offen offset:1024 sc1
    s_add_u32 s51, s51, 2048
    s_nop 0
    s_waitcnt lgkmcnt(4)
    v_mfma_f32_16x16x32_bf16 v[16:19], v[224:227], v[140:143], v[16:19]
    ds_read_b64_tr_b16 v[236:237], v243 offset:12288
    ds_read_b64_tr_b16 v[238:239], v243 offset:12800
    v_mfma_f32_16x16x32_bf16 v[20:23], v[224:227], v[172:175], v[20:23]
    s_waitcnt lgkmcnt(4)
    v_mfma_f32_16x16x32_bf16 v[24:27], v[228:231], v[140:143], v[24:27]
    s_add_u32 s35, s35, 34816
    s_cmp_ge_u32 s35, 139264
    s_cselect_b32 s40, 139264, 0
    s_sub_u32 s35, s35, s40
    v_add_u32 v242, s35, v240
    v_xor_b32 v243, 32, v242
    v_xor_b32 v244, 64, v242
    v_xor_b32 v241, 96, v242
    ds_read_b64_tr_b16 v[224:225], v244 offset:0
    ds_read_b64_tr_b16 v[226:227], v244 offset:512
    v_mfma_f32_16x16x32_bf16 v[28:31], v[228:231], v[172:175], v[28:31]
    s_add_u32 s38, s47, 351232
    s_add_u32 m0, s55, 18432
    s_nop 0
    buffer_load_dwordx4 v246, s[24:27], s38 offen lds
    s_add_u32 s47, s47, 128
    s_waitcnt lgkmcnt(4)
    v_mfma_f32_16x16x32_bf16 v[0:3], v[232:235], v[140:143], v[0:3]
    ds_read_b64_tr_b16 v[228:229], v241 offset:0
    ds_read_b64_tr_b16 v[230:231], v241 offset:512
    v_mfma_f32_16x16x32_bf16 v[4:7], v[232:235], v[172:175], v[4:7]
    s_waitcnt lgkmcnt(4)
    v_mfma_f32_16x16x32_bf16 v[8:11], v[236:239], v[140:143], v[8:11]
    ds_read_b64_tr_b16 v[232:233], v242 offset:0
    ds_read_b64_tr_b16 v[234:235], v242 offset:512
    v_mfma_f32_16x16x32_bf16 v[12:15], v[236:239], v[172:175], v[12:15]
    s_waitcnt lgkmcnt(4)
    v_mfma_f32_16x16x32_bf16 v[16:19], v[224:227], v[144:147], v[16:19]
    ds_read_b64_tr_b16 v[236:237], v243 offset:0
    ds_read_b64_tr_b16 v[238:239], v243 offset:512
    v_mfma_f32_16x16x32_bf16 v[20:23], v[224:227], v[176:179], v[20:23]
    s_waitcnt lgkmcnt(4)
    v_mfma_f32_16x16x32_bf16 v[24:27], v[228:231], v[144:147], v[24:27]
    ds_read_b64_tr_b16 v[224:225], v244 offset:4096
    ds_read_b64_tr_b16 v[226:227], v244 offset:4608
    v_mfma_f32_16x16x32_bf16 v[28:31], v[228:231], v[176:179], v[28:31]
    s_waitcnt lgkmcnt(4)
    v_mfma_f32_16x16x32_bf16 v[0:3], v[232:235], v[144:147], v[0:3]
    ds_read_b64_tr_b16 v[228:229], v241 offset:4096
    ds_read_b64_tr_b16 v[230:231], v241 offset:4608
    v_mfma_f32_16x16x32_bf16 v[4:7], v[232:235], v[176:179], v[4:7]
    s_waitcnt lgkmcnt(4)
    v_mfma_f32_16x16x32_bf16 v[8:11], v[236:239], v[144:147], v[8:11]
    ds_read_b64_tr_b16 v[232:233], v242 offset:4096
    ds_read_b64_tr_b16 v[234:235], v242 offset:4608
    v_mfma_f32_16x16x32_bf16 v[12:15], v[236:239], v[176:179], v[12:15]
    s_waitcnt lgkmcnt(4)
    v_mfma_f32_16x16x32_bf16 v[16:19], v[224:227], v[148:151], v[16:19]
    ds_read_b64_tr_b16 v[236:237], v243 offset:4096
    ds_read_b64_tr_b16 v[238:239], v243 offset:4608
    v_mfma_f32_16x16x32_bf16 v[20:23], v[224:227], v[180:183], v[20:23]
    s_waitcnt lgkmcnt(4)
    v_mfma_f32_16x16x32_bf16 v[24:27], v[228:231], v[148:151], v[24:27]
    ds_read_b64_tr_b16 v[224:225], v244 offset:8192
    ds_read_b64_tr_b16 v[226:227], v244 offset:8704
    v_mfma_f32_16x16x32_bf16 v[28:31], v[228:231], v[180:183], v[28:31]
    s_waitcnt vmcnt(4)
    s_barrier
    s_add_u32 s55, s36, s50
    s_add_u32 s36, s36, 34816
    s_cmp_ge_u32 s36, 139264
    s_cselect_b32 s40, 139264, 0
    s_sub_u32 s36, s36, s40
    s_waitcnt lgkmcnt(4)
    v_mfma_f32_16x16x32_bf16 v[0:3], v[232:235], v[148:151], v[0:3]
    ds_read_b64_tr_b16 v[228:229], v241 offset:8192
    ds_read_b64_tr_b16 v[230:231], v241 offset:8704
    v_mfma_f32_16x16x32_bf16 v[4:7], v[232:235], v[180:183], v[4:7]
    s_waitcnt lgkmcnt(4)
    v_mfma_f32_16x16x32_bf16 v[8:11], v[236:239], v[148:151], v[8:11]
    ds_read_b64_tr_b16 v[232:233], v242 offset:8192
    ds_read_b64_tr_b16 v[234:235], v242 offset:8704
    v_mfma_f32_16x16x32_bf16 v[12:15], v[236:239], v[180:183], v[12:15]
    s_add_u32 s38, s47, 0
    s_add_u32 m0, s55, 0
    s_nop 0
    buffer_load_dwordx4 v247, s[24:27], s38 offen lds
    s_waitcnt lgkmcnt(4)
    v_mfma_f32_16x16x32_bf16 v[16:19], v[224:227], v[152:155], v[16:19]
    ds_read_b64_tr_b16 v[236:237], v243 offset:8192
    ds_read_b64_tr_b16 v[238:239], v243 offset:8704
    v_mfma_f32_16x16x32_bf16 v[20:23], v[224:227], v[184:187], v[20:23]
    s_waitcnt lgkmcnt(4)
    v_mfma_f32_16x16x32_bf16 v[24:27], v[228:231], v[152:155], v[24:27]
    ds_read_b64_tr_b16 v[224:225], v244 offset:12288
    ds_read_b64_tr_b16 v[226:227], v244 offset:12800
    v_mfma_f32_16x16x32_bf16 v[28:31], v[228:231], v[184:187], v[28:31]
    s_add_u32 s38, s47, 7168
    s_add_u32 m0, s55, 1024
    s_nop 0
    buffer_load_dwordx4 v246, s[24:27], s38 offen lds
    s_waitcnt lgkmcnt(4)
    v_mfma_f32_16x16x32_bf16 v[0:3], v[232:235], v[152:155], v[0:3]
    ds_read_b64_tr_b16 v[228:229], v241 offset:12288
    ds_read_b64_tr_b16 v[230:231], v241 offset:12800
    v_mfma_f32_16x16x32_bf16 v[4:7], v[232:235], v[184:187], v[4:7]
    s_waitcnt lgkmcnt(4)
    v_mfma_f32_16x16x32_bf16 v[8:11], v[236:239], v[152:155], v[8:11]
    ds_read_b64_tr_b16 v[232:233], v242 offset:12288
    ds_read_b64_tr_b16 v[234:235], v242 offset:12800
    v_mfma_f32_16x16x32_bf16 v[12:15], v[236:239], v[184:187], v[12:15]
    s_add_u32 s38, s47, 229376
    s_add_u32 m0, s55, 17408
    s_nop 0
    buffer_load_dwordx4 v247, s[24:27], s38 offen lds
    s_waitcnt lgkmcnt(4)
    v_mfma_f32_16x16x32_bf16 v[16:19], v[224:227], v[156:159], v[16:19]
    ds_read_b64_tr_b16 v[236:237], v243 offset:12288
    ds_read_b64_tr_b16 v[238:239], v243 offset:12800
    v_mfma_f32_16x16x32_bf16 v[20:23], v[224:227], v[188:191], v[20:23]
    s_waitcnt lgkmcnt(4)
    v_mfma_f32_16x16x32_bf16 v[24:27], v[228:231], v[156:159], v[24:27]
    s_add_u32 s35, s35, 34816
    s_cmp_ge_u32 s35, 139264
    s_cselect_b32 s40, 139264, 0
    s_sub_u32 s35, s35, s40
    v_add_u32 v242, s35, v240
    v_xor_b32 v243, 32, v242
    v_xor_b32 v244, 64, v242
    v_xor_b32 v241, 96, v242
    ds_read_b64_tr_b16 v[224:225], v244 offset:0
    ds_read_b64_tr_b16 v[226:227], v244 offset:512
    v_mfma_f32_16x16x32_bf16 v[28:31], v[228:231], v[188:191], v[28:31]
    s_add_u32 s38, s47, 236544
    s_add_u32 m0, s55, 18432
    s_nop 0
    buffer_load_dwordx4 v246, s[24:27], s38 offen lds
    s_waitcnt lgkmcnt(4)
    v_mfma_f32_16x16x32_bf16 v[0:3], v[232:235], v[156:159], v[0:3]
    ds_read_b64_tr_b16 v[228:229], v241 offset:0
    ds_read_b64_tr_b16 v[230:231], v241 offset:512
    v_mfma_f32_16x16x32_bf16 v[4:7], v[232:235], v[188:191], v[4:7]
    s_waitcnt lgkmcnt(4)
    v_mfma_f32_16x16x32_bf16 v[8:11], v[236:239], v[156:159], v[8:11]
    ds_read_b64_tr_b16 v[232:233], v242 offset:0
    ds_read_b64_tr_b16 v[234:235], v242 offset:512
    v_mfma_f32_16x16x32_bf16 v[12:15], v[236:239], v[188:191], v[12:15]
    s_waitcnt lgkmcnt(4)
    v_mfma_f32_16x16x32_bf16 v[208:211], v[224:227], v[128:131], 0
    ds_read_b64_tr_b16 v[236:237], v243 offset:0
    ds_read_b64_tr_b16 v[238:239], v243 offset:512
    v_mfma_f32_16x16x32_bf16 v[212:215], v[224:227], v[160:163], 0
    s_waitcnt lgkmcnt(4)
    v_mfma_f32_16x16x32_bf16 v[216:219], v[228:231], v[128:131], 0
    ds_read_b64_tr_b16 v[224:225], v244 offset:4096
    ds_read_b64_tr_b16 v[226:227], v244 offset:4608
    ds_write_b128 v56, v[16:19]
    ds_write_b128 v57, v[20:23]
    ds_write_b128 v58, v[24:27]
    v_mfma_f32_16x16x32_bf16 v[220:223], v[228:231], v[160:163], 0
    ds_write_b128 v59, v[28:31]
    s_waitcnt lgkmcnt(8)
    v_mfma_f32_16x16x32_bf16 v[192:195], v[232:235], v[128:131], 0
    ds_read_b64_tr_b16 v[228:229], v241 offset:4096
    ds_read_b64_tr_b16 v[230:231], v241 offset:4608
    v_mfma_f32_16x16x32_bf16 v[196:199], v[232:235], v[160:163], 0
    s_waitcnt lgkmcnt(8)
    v_mfma_f32_16x16x32_bf16 v[200:203], v[236:239], v[128:131], 0
    ds_read_b64_tr_b16 v[232:233], v242 offset:4096
    ds_read_b64_tr_b16 v[234:235], v242 offset:4608
    v_mfma_f32_16x16x32_bf16 v[204:207], v[236:239], v[160:163], 0
    s_waitcnt lgkmcnt(8)
    v_mfma_f32_16x16x32_bf16 v[208:211], v[224:227], v[132:135], v[208:211]
    ds_read_b64_tr_b16 v[236:237], v243 offset:4096
    ds_read_b64_tr_b16 v[238:239], v243 offset:4608
    v_mfma_f32_16x16x32_bf16 v[212:215], v[224:227], v[164:167], v[212:215]
    s_waitcnt lgkmcnt(4)
    v_mfma_f32_16x16x32_bf16 v[216:219], v[228:231], v[132:135], v[216:219]
    ds_read_b64_tr_b16 v[224:225], v244 offset:8192
    ds_read_b64_tr_b16 v[226:227], v244 offset:8704
    v_mfma_f32_16x16x32_bf16 v[220:223], v[228:231], v[164:167], v[220:223]
    s_waitcnt vmcnt(4)
    s_barrier
    s_add_u32 s55, s36, s50
    s_add_u32 s36, s36, 34816
    s_cmp_ge_u32 s36, 139264
    s_cselect_b32 s40, 139264, 0
    s_sub_u32 s36, s36, s40
    s_waitcnt lgkmcnt(4)
    v_mfma_f32_16x16x32_bf16 v[192:195], v[232:235], v[132:135], v[192:195]
    ds_read_b64_tr_b16 v[228:229], v241 offset:8192
    ds_read_b64_tr_b16 v[230:231], v241 offset:8704
    ds_read_b128 v[32:35], v60
    ds_read_b128 v[36:39], v61
    ds_read_b128 v[40:43], v62
    v_mfma_f32_16x16x32_bf16 v[196:199], v[232:235], v[164:167], v[196:199]
    ds_read_b128 v[44:47], v63
    s_waitcnt lgkmcnt(8)
    v_mfma_f32_16x16x32_bf16 v[200:203], v[236:239], v[132:135], v[200:203]
    ds_read_b64_tr_b16 v[232:233], v242 offset:8192
    ds_read_b64_tr_b16 v[234:235], v242 offset:8704
    v_mfma_f32_16x16x32_bf16 v[204:207], v[236:239], v[164:167], v[204:207]
    s_add_u32 s38, s47, 114688
    s_add_u32 m0, s55, 0
    s_nop 0
    buffer_load_dwordx4 v247, s[24:27], s38 offen lds
    s_waitcnt lgkmcnt(2)
    v_add_f32 v32, v32, v0
    v_mfma_f32_16x16x32_bf16 v[208:211], v[224:227], v[136:139], v[208:211]
    ds_read_b64_tr_b16 v[236:237], v243 offset:8192
    ds_read_b64_tr_b16 v[238:239], v243 offset:8704
    v_add_f32 v33, v33, v1
    v_add_f32 v34, v34, v2
    v_add_f32 v35, v35, v3
    v_mfma_f32_16x16x32_bf16 v[212:215], v[224:227], v[168:171], v[212:215]
    v_add_f32 v36, v36, v4
    v_add_f32 v37, v37, v5
    v_add_f32 v38, v38, v6
    v_mfma_f32_16x16x32_bf16 v[216:219], v[228:231], v[136:139], v[216:219]
    ds_read_b64_tr_b16 v[224:225], v244 offset:12288
    ds_read_b64_tr_b16 v[226:227], v244 offset:12800
    v_add_f32 v39, v39, v7
    v_add_f32 v40, v40, v8
    v_add_f32 v41, v41, v9
    v_mfma_f32_16x16x32_bf16 v[220:223], v[228:231], v[168:171], v[220:223]
    s_add_u32 s38, s47, 121856
    s_add_u32 m0, s55, 1024
    s_nop 0
    buffer_load_dwordx4 v246, s[24:27], s38 offen lds
    v_add_f32 v42, v42, v10
    v_add_f32 v43, v43, v11
    v_add_f32 v44, v44, v12
    s_waitcnt lgkmcnt(4)
    v_mfma_f32_16x16x32_bf16 v[192:195], v[232:235], v[136:139], v[192:195]
    ds_read_b64_tr_b16 v[228:229], v241 offset:12288
    ds_read_b64_tr_b16 v[230:231], v241 offset:12800
    v_add_f32 v45, v45, v13
    v_add_f32 v46, v46, v14
    v_add_f32 v47, v47, v15
    v_mfma_f32_16x16x32_bf16 v[196:199], v[232:235], v[168:171], v[196:199]
    v_cvt_pk_bf16_f32 v48, v32, v33
    v_cvt_pk_bf16_f32 v49, v34, v35
    v_cvt_pk_bf16_f32 v52, v36, v37
    s_waitcnt lgkmcnt(4)
    v_mfma_f32_16x16x32_bf16 v[200:203], v[236:239], v[136:139], v[200:203]
    ds_read_b64_tr_b16 v[232:233], v242 offset:12288
    ds_read_b64_tr_b16 v[234:235], v242 offset:12800
    v_cvt_pk_bf16_f32 v53, v38, v39
    v_cvt_pk_bf16_f32 v50, v40, v41
    v_cvt_pk_bf16_f32 v51, v42, v43
    v_mfma_f32_16x16x32_bf16 v[204:207], v[236:239], v[168:171], v[204:207]
    s_add_u32 s38, s47, 344064
    s_add_u32 m0, s55, 17408
    s_nop 0
    buffer_load_dwordx4 v247, s[24:27], s38 offen lds
    v_cvt_pk_bf16_f32 v54, v44, v45
    v_cvt_pk_bf16_f32 v55, v46, v47
    buffer_store_dwordx4 v[48:51], v245, s[28:31], s51 offen offset:0 sc1
    buffer_store_dwordx4 v[52:55], v245, s[28:31], s51 offen offset:1024 sc1
    s_add_u32 s51, s51, 2048
    s_nop 0
    s_waitcnt lgkmcnt(4)
    v_mfma_f32_16x16x32_bf16 v[208:211], v[224:227], v[140:143], v[208:211]
    ds_read_b64_tr_b16 v[236:237], v243 offset:12288
    ds_read_b64_tr_b16 v[238:239], v243 offset:12800
    v_mfma_f32_16x16x32_bf16 v[212:215], v[224:227], v[172:175], v[212:215]
    s_waitcnt lgkmcnt(4)
    v_mfma_f32_16x16x32_bf16 v[216:219], v[228:231], v[140:143], v[216:219]
    s_add_u32 s35, s35, 34816
    s_cmp_ge_u32 s35, 139264
    s_cselect_b32 s40, 139264, 0
    s_sub_u32 s35, s35, s40
    v_add_u32 v242, s35, v240
    v_xor_b32 v243, 32, v242
    v_xor_b32 v244, 64, v242
    v_xor_b32 v241, 96, v242
    ds_read_b64_tr_b16 v[224:225], v244 offset:0
    ds_read_b64_tr_b16 v[226:227], v244 offset:512
    v_mfma_f32_16x16x32_bf16 v[220:223], v[228:231], v[172:175], v[220:223]
    s_add_u32 s38, s47, 351232
    s_add_u32 m0, s55, 18432
    s_nop 0
    buffer_load_dwordx4 v246, s[24:27], s38 offen lds
    s_add_u32 s47, s47, 128
    s_waitcnt lgkmcnt(4)
    v_mfma_f32_16x16x32_bf16 v[192:195], v[232:235], v[140:143], v[192:195]
    ds_read_b64_tr_b16 v[228:229], v241 offset:0
    ds_read_b64_tr_b16 v[230:231], v241 offset:512
    v_mfma_f32_16x16x32_bf16 v[196:199], v[232:235], v[172:175], v[196:199]
    s_waitcnt lgkmcnt(4)
    v_mfma_f32_16x16x32_bf16 v[200:203], v[236:239], v[140:143], v[200:203]
    ds_read_b64_tr_b16 v[232:233], v242 offset:0
    ds_read_b64_tr_b16 v[234:235], v242 offset:512
    v_mfma_f32_16x16x32_bf16 v[204:207], v[236:239], v[172:175], v[204:207]
    s_waitcnt lgkmcnt(4)
    v_mfma_f32_16x16x32_bf16 v[208:211], v[224:227], v[144:147], v[208:211]
    ds_read_b64_tr_b16 v[236:237], v243 offset:0
    ds_read_b64_tr_b16 v[238:239], v243 offset:512
    v_mfma_f32_16x16x32_bf16 v[212:215], v[224:227], v[176:179], v[212:215]
    s_waitcnt lgkmcnt(4)
    v_mfma_f32_16x16x32_bf16 v[216:219], v[228:231], v[144:147], v[216:219]
    ds_read_b64_tr_b16 v[224:225], v244 offset:4096
    ds_read_b64_tr_b16 v[226:227], v244 offset:4608
    v_mfma_f32_16x16x32_bf16 v[220:223], v[228:231], v[176:179], v[220:223]
    s_waitcnt lgkmcnt(4)
    v_mfma_f32_16x16x32_bf16 v[192:195], v[232:235], v[144:147], v[192:195]
    ds_read_b64_tr_b16 v[228:229], v241 offset:4096
    ds_read_b64_tr_b16 v[230:231], v241 offset:4608
    v_mfma_f32_16x16x32_bf16 v[196:199], v[232:235], v[176:179], v[196:199]
    s_waitcnt lgkmcnt(4)
    v_mfma_f32_16x16x32_bf16 v[200:203], v[236:239], v[144:147], v[200:203]
    ds_read_b64_tr_b16 v[232:233], v242 offset:4096
    ds_read_b64_tr_b16 v[234:235], v242 offset:4608
    v_mfma_f32_16x16x32_bf16 v[204:207], v[236:239], v[176:179], v[204:207]
    s_waitcnt lgkmcnt(4)
    v_mfma_f32_16x16x32_bf16 v[208:211], v[224:227], v[148:151], v[208:211]
    ds_read_b64_tr_b16 v[236:237], v243 offset:4096
    ds_read_b64_tr_b16 v[238:239], v243 offset:4608
    v_mfma_f32_16x16x32_bf16 v[212:215], v[224:227], v[180:183], v[212:215]
    s_waitcnt lgkmcnt(4)
    v_mfma_f32_16x16x32_bf16 v[216:219], v[228:231], v[148:151], v[216:219]
    ds_read_b64_tr_b16 v[224:225], v244 offset:8192
    ds_read_b64_tr_b16 v[226:227], v244 offset:8704
    v_mfma_f32_16x16x32_bf16 v[220:223], v[228:231], v[180:183], v[220:223]
    s_waitcnt vmcnt(4)
    s_barrier
    s_add_u32 s55, s36, s50
    s_add_u32 s36, s36, 34816
    s_cmp_ge_u32 s36, 139264
    s_cselect_b32 s40, 139264, 0
    s_sub_u32 s36, s36, s40
    s_waitcnt lgkmcnt(4)
    v_mfma_f32_16x16x32_bf16 v[192:195], v[232:235], v[148:151], v[192:195]
    ds_read_b64_tr_b16 v[228:229], v241 offset:8192
    ds_read_b64_tr_b16 v[230:231], v241 offset:8704
    v_mfma_f32_16x16x32_bf16 v[196:199], v[232:235], v[180:183], v[196:199]
    s_waitcnt lgkmcnt(4)
    v_mfma_f32_16x16x32_bf16 v[200:203], v[236:239], v[148:151], v[200:203]
    ds_read_b64_tr_b16 v[232:233], v242 offset:8192
    ds_read_b64_tr_b16 v[234:235], v242 offset:8704
    v_mfma_f32_16x16x32_bf16 v[204:207], v[236:239], v[180:183], v[204:207]
    s_add_u32 s38, s47, 0
    s_add_u32 m0, s55, 0
    s_nop 0
    buffer_load_dwordx4 v247, s[24:27], s38 offen lds
    s_waitcnt lgkmcnt(4)
    v_mfma_f32_16x16x32_bf16 v[208:211], v[224:227], v[152:155], v[208:211]
    ds_read_b64_tr_b16 v[236:237], v243 offset:8192
    ds_read_b64_tr_b16 v[238:239], v243 offset:8704
    v_mfma_f32_16x16x32_bf16 v[212:215], v[224:227], v[184:187], v[212:215]
    s_waitcnt lgkmcnt(4)
    v_mfma_f32_16x16x32_bf16 v[216:219], v[228:231], v[152:155], v[216:219]
    ds_read_b64_tr_b16 v[224:225], v244 offset:12288
    ds_read_b64_tr_b16 v[226:227], v244 offset:12800
    v_mfma_f32_16x16x32_bf16 v[220:223], v[228:231], v[184:187], v[220:223]
    s_add_u32 s38, s47, 7168
    s_add_u32 m0, s55, 1024
    s_nop 0
    buffer_load_dwordx4 v246, s[24:27], s38 offen lds
    s_waitcnt lgkmcnt(4)
    v_mfma_f32_16x16x32_bf16 v[192:195], v[232:235], v[152:155], v[192:195]
    ds_read_b64_tr_b16 v[228:229], v241 offset:12288
    ds_read_b64_tr_b16 v[230:231], v241 offset:12800
    v_mfma_f32_16x16x32_bf16 v[196:199], v[232:235], v[184:187], v[196:199]
    s_waitcnt lgkmcnt(4)
    v_mfma_f32_16x16x32_bf16 v[200:203], v[236:239], v[152:155], v[200:203]
    ds_read_b64_tr_b16 v[232:233], v242 offset:12288
    ds_read_b64_tr_b16 v[234:235], v242 offset:12800
    v_mfma_f32_16x16x32_bf16 v[204:207], v[236:239], v[184:187], v[204:207]
    s_add_u32 s38, s47, 229376
    s_add_u32 m0, s55, 17408
    s_nop 0
    buffer_load_dwordx4 v247, s[24:27], s38 offen lds
    s_waitcnt lgkmcnt(4)
    v_mfma_f32_16x16x32_bf16 v[208:211], v[224:227], v[156:159], v[208:211]
    ds_read_b64_tr_b16 v[236:237], v243 offset:12288
    ds_read_b64_tr_b16 v[238:239], v243 offset:12800
    v_mfma_f32_16x16x32_bf16 v[212:215], v[224:227], v[188:191], v[212:215]
    s_waitcnt lgkmcnt(4)
    v_mfma_f32_16x16x32_bf16 v[216:219], v[228:231], v[156:159], v[216:219]
    s_add_u32 s35, s35, 34816
    s_cmp_ge_u32 s35, 139264
    s_cselect_b32 s40, 139264, 0
    s_sub_u32 s35, s35, s40
    v_add_u32 v242, s35, v240
    v_xor_b32 v243, 32, v242
    v_xor_b32 v244, 64, v242
    v_xor_b32 v241, 96, v242
    ds_read_b64_tr_b16 v[224:225], v244 offset:0
    ds_read_b64_tr_b16 v[226:227], v244 offset:512
    v_mfma_f32_16x16x32_bf16 v[220:223], v[228:231], v[188:191], v[220:223]
    s_add_u32 s38, s47, 236544
    s_add_u32 m0, s55, 18432
    s_nop 0
    buffer_load_dwordx4 v246, s[24:27], s38 offen lds
    s_waitcnt lgkmcnt(4)
    v_mfma_f32_16x16x32_bf16 v[192:195], v[232:235], v[156:159], v[192:195]
    ds_read_b64_tr_b16 v[228:229], v241 offset:0
    ds_read_b64_tr_b16 v[230:231], v241 offset:512
    v_mfma_f32_16x16x32_bf16 v[196:199], v[232:235], v[188:191], v[196:199]
    s_waitcnt lgkmcnt(4)
    v_mfma_f32_16x16x32_bf16 v[200:203], v[236:239], v[156:159], v[200:203]
    ds_read_b64_tr_b16 v[232:233], v242 offset:0
    ds_read_b64_tr_b16 v[234:235], v242 offset:512
    v_mfma_f32_16x16x32_bf16 v[204:207], v[236:239], v[188:191], v[204:207]
    s_sub_u32 s41, s41, 1
    s_cmp_lg_u32 s41, 0
    s_cbranch_scc1 L_p3
    s_waitcnt lgkmcnt(4)
    v_mfma_f32_16x16x32_bf16 v[16:19], v[224:227], v[128:131], 0
    ds_read_b64_tr_b16 v[236:237], v243 offset:0
    ds_read_b64_tr_b16 v[238:239], v243 offset:512
    v_mfma_f32_16x16x32_bf16 v[20:23], v[224:227], v[160:163], 0
    s_waitcnt lgkmcnt(4)
    v_mfma_f32_16x16x32_bf16 v[24:27], v[228:231], v[128:131], 0
    ds_read_b64_tr_b16 v[224:225], v244 offset:4096
    ds_read_b64_tr_b16 v[226:227], v244 offset:4608
    ds_write_b128 v56, v[208:211]
    ds_write_b128 v57, v[212:215]
    ds_write_b128 v58, v[216:219]
    v_mfma_f32_16x16x32_bf16 v[28:31], v[228:231], v[160:163], 0
    ds_write_b128 v59, v[220:223]
    s_waitcnt lgkmcnt(8)
    v_mfma_f32_16x16x32_bf16 v[0:3], v[232:235], v[128:131], 0
    ds_read_b64_tr_b16 v[228:229], v241 offset:4096
    ds_read_b64_tr_b16 v[230:231], v241 offset:4608
    v_mfma_f32_16x16x32_bf16 v[4:7], v[232:235], v[160:163], 0
    s_waitcnt lgkmcnt(8)
    v_mfma_f32_16x16x32_bf16 v[8:11], v[236:239], v[128:131], 0
    ds_read_b64_tr_b16 v[232:233], v242 offset:4096
    ds_read_b64_tr_b16 v[234:235], v242 offset:4608
    v_mfma_f32_16x16x32_bf16 v[12:15], v[236:239], v[160:163], 0
    s_waitcnt lgkmcnt(8)
    v_mfma_f32_16x16x32_bf16 v[16:19], v[224:227], v[132:135], v[16:19]
    ds_read_b64_tr_b16 v[236:237], v243 offset:4096
    ds_read_b64_tr_b16 v[238:239], v243 offset:4608
    v_mfma_f32_16x16x32_bf16 v[20:23], v[224:227], v[164:167], v[20:23]
    s_waitcnt lgkmcnt(4)
    v_mfma_f32_16x16x32_bf16 v[24:27], v[228:231], v[132:135], v[24:27]
    ds_read_b64_tr_b16 v[224:225], v244 offset:8192
    ds_read_b64_tr_b16 v[226:227], v244 offset:8704
    v_mfma_f32_16x16x32_bf16 v[28:31], v[228:231], v[164:167], v[28:31]
    s_waitcnt vmcnt(4)
    s_barrier
    s_add_u32 s55, s36, s50
    s_add_u32 s36, s36, 34816
    s_cmp_ge_u32 s36, 139264
    s_cselect_b32 s40, 139264, 0
    s_sub_u32 s36, s36, s40
    s_waitcnt lgkmcnt(4)
    v_mfma_f32_16x16x32_bf16 v[0:3], v[232:235], v[132:135], v[0:3]
    ds_read_b64_tr_b16 v[228:229], v241 offset:8192
    ds_read_b64_tr_b16 v[230:231], v241 offset:8704
    ds_read_b128 v[32:35], v60
    ds_read_b128 v[36:39], v61
    ds_read_b128 v[40:43], v62
    v_mfma_f32_16x16x32_bf16 v[4:7], v[232:235], v[164:167], v[4:7]
    ds_read_b128 v[44:47], v63
    s_waitcnt lgkmcnt(8)
    v_mfma_f32_16x16x32_bf16 v[8:11], v[236:239], v[132:135], v[8:11]
    ds_read_b64_tr_b16 v[232:233], v242 offset:8192
    ds_read_b64_tr_b16 v[234:235], v242 offset:8704
    v_mfma_f32_16x16x32_bf16 v[12:15], v[236:239], v[164:167], v[12:15]
    s_add_u32 s38, s47, 114688
    s_add_u32 m0, s55, 0
    s_nop 0
    buffer_load_dwordx4 v247, s[24:27], s38 offen lds
    s_waitcnt lgkmcnt(2)
    v_add_f32 v32, v32, v192
    v_mfma_f32_16x16x32_bf16 v[16:19], v[224:227], v[136:139], v[16:19]
    ds_read_b64_tr_b16 v[236:237], v243 offset:8192
    ds_read_b64_tr_b16 v[238:239], v243 offset:8704
    v_add_f32 v33, v33, v193
    v_add_f32 v34, v34, v194
    v_add_f32 v35, v35, v195
    v_mfma_f32_16x16x32_bf16 v[20:23], v[224:227], v[168:171], v[20:23]
    v_add_f32 v36, v36, v196
    v_add_f32 v37, v37, v197
    v_add_f32 v38, v38, v198
    v_mfma_f32_16x16x32_bf16 v[24:27], v[228:231], v[136:139], v[24:27]
    ds_read_b64_tr_b16 v[224:225], v244 offset:12288
    ds_read_b64_tr_b16 v[226:227], v244 offset:12800
    v_add_f32 v39, v39, v199
    v_add_f32 v40, v40, v200
    v_add_f32 v41, v41, v201
    v_mfma_f32_16x16x32_bf16 v[28:31], v[228:231], v[168:171], v[28:31]
    s_add_u32 s38, s47, 121856
    s_add_u32 m0, s55, 1024
    s_nop 0
    buffer_load_dwordx4 v246, s[24:27], s38 offen lds
    v_add_f32 v42, v42, v202
    v_add_f32 v43, v43, v203
    v_add_f32 v44, v44, v204
    s_waitcnt lgkmcnt(4)
    v_mfma_f32_16x16x32_bf16 v[0:3], v[232:235], v[136:139], v[0:3]
    ds_read_b64_tr_b16 v[228:229], v241 offset:12288
    ds_read_b64_tr_b16 v[230:231], v241 offset:12800
    v_add_f32 v45, v45, v205
    v_add_f32 v46, v46, v206
    v_add_f32 v47, v47, v207
    v_mfma_f32_16x16x32_bf16 v[4:7], v[232:235], v[168:171], v[4:7]
    v_cvt_pk_bf16_f32 v48, v32, v33
    v_cvt_pk_bf16_f32 v49, v34, v35
    v_cvt_pk_bf16_f32 v52, v36, v37
    s_waitcnt lgkmcnt(4)
    v_mfma_f32_16x16x32_bf16 v[8:11], v[236:239], v[136:139], v[8:11]
    ds_read_b64_tr_b16 v[232:233], v242 offset:12288
    ds_read_b64_tr_b16 v[234:235], v242 offset:12800
    v_cvt_pk_bf16_f32 v53, v38, v39
    v_cvt_pk_bf16_f32 v50, v40, v41
    v_cvt_pk_bf16_f32 v51, v42, v43
    v_mfma_f32_16x16x32_bf16 v[12:15], v[236:239], v[168:171], v[12:15]
    s_add_u32 s38, s47, 344064
    s_add_u32 m0, s55, 17408
    s_nop 0
    buffer_load_dwordx4 v247, s[24:27], s38 offen lds
    v_cvt_pk_bf16_f32 v54, v44, v45
    v_cvt_pk_bf16_f32 v55, v46, v47
    buffer_store_dwordx4 v[48:51], v245, s[28:31], s51 offen offset:0 sc1
    buffer_store_dwordx4 v[52:55], v245, s[28:31], s51 offen offset:1024 sc1
    s_add_u32 s51, s51, 2048
    s_nop 0
    s_waitcnt lgkmcnt(4)
    v_mfma_f32_16x16x32_bf16 v[16:19], v[224:227], v[140:143], v[16:19]
    ds_read_b64_tr_b16 v[236:237], v243 offset:12288
    ds_read_b64_tr_b16 v[238:239], v243 offset:12800
    v_mfma_f32_16x16x32_bf16 v[20:23], v[224:227], v[172:175], v[20:23]
    s_waitcnt lgkmcnt(4)
    v_mfma_f32_16x16x32_bf16 v[24:27], v[228:231], v[140:143], v[24:27]
    s_add_u32 s35, s35, 34816
    s_cmp_ge_u32 s35, 139264
    s_cselect_b32 s40, 139264, 0
    s_sub_u32 s35, s35, s40
    v_add_u32 v242, s35, v240
    v_xor_b32 v243, 32, v242
    v_xor_b32 v244, 64, v242
    v_xor_b32 v241, 96, v242
    ds_read_b64_tr_b16 v[224:225], v244 offset:0
    ds_read_b64_tr_b16 v[226:227], v244 offset:512
    v_mfma_f32_16x16x32_bf16 v[28:31], v[228:231], v[172:175], v[28:31]
    s_add_u32 s38, s47, 351232
    s_add_u32 m0, s55, 18432
    s_nop 0
    buffer_load_dwordx4 v246, s[24:27], s38 offen lds
    s_add_u32 s47, s47, 128
    s_waitcnt lgkmcnt(4)
    v_mfma_f32_16x16x32_bf16 v[0:3], v[232:235], v[140:143], v[0:3]
    ds_read_b64_tr_b16 v[228:229], v241 offset:0
    ds_read_b64_tr_b16 v[230:231], v241 offset:512
    v_mfma_f32_16x16x32_bf16 v[4:7], v[232:235], v[172:175], v[4:7]
    s_waitcnt lgkmcnt(4)
    v_mfma_f32_16x16x32_bf16 v[8:11], v[236:239], v[140:143], v[8:11]
    ds_read_b64_tr_b16 v[232:233], v242 offset:0
    ds_read_b64_tr_b16 v[234:235], v242 offset:512
    v_mfma_f32_16x16x32_bf16 v[12:15], v[236:239], v[172:175], v[12:15]
    s_waitcnt lgkmcnt(4)
    v_mfma_f32_16x16x32_bf16 v[16:19], v[224:227], v[144:147], v[16:19]
    ds_read_b64_tr_b16 v[236:237], v243 offset:0
    ds_read_b64_tr_b16 v[238:239], v243 offset:512
    v_mfma_f32_16x16x32_bf16 v[20:23], v[224:227], v[176:179], v[20:23]
    s_waitcnt lgkmcnt(4)
    v_mfma_f32_16x16x32_bf16 v[24:27], v[228:231], v[144:147], v[24:27]
    ds_read_b64_tr_b16 v[224:225], v244 offset:4096
    ds_read_b64_tr_b16 v[226:227], v244 offset:4608
    v_mfma_f32_16x16x32_bf16 v[28:31], v[228:231], v[176:179], v[28:31]
    s_waitcnt lgkmcnt(4)
    v_mfma_f32_16x16x32_bf16 v[0:3], v[232:235], v[144:147], v[0:3]
    ds_read_b64_tr_b16 v[228:229], v241 offset:4096
    ds_read_b64_tr_b16 v[230:231], v241 offset:4608
    v_mfma_f32_16x16x32_bf16 v[4:7], v[232:235], v[176:179], v[4:7]
    s_waitcnt lgkmcnt(4)
    v_mfma_f32_16x16x32_bf16 v[8:11], v[236:239], v[144:147], v[8:11]
    ds_read_b64_tr_b16 v[232:233], v242 offset:4096
    ds_read_b64_tr_b16 v[234:235], v242 offset:4608
    v_mfma_f32_16x16x32_bf16 v[12:15], v[236:239], v[176:179], v[12:15]
    s_waitcnt lgkmcnt(4)
    v_mfma_f32_16x16x32_bf16 v[16:19], v[224:227], v[148:151], v[16:19]
    ds_read_b64_tr_b16 v[236:237], v243 offset:4096
    ds_read_b64_tr_b16 v[238:239], v243 offset:4608
    v_mfma_f32_16x16x32_bf16 v[20:23], v[224:227], v[180:183], v[20:23]
    s_waitcnt lgkmcnt(4)
    v_mfma_f32_16x16x32_bf16 v[24:27], v[228:231], v[148:151], v[24:27]
    ds_read_b64_tr_b16 v[224:225], v244 offset:8192
    ds_read_b64_tr_b16 v[226:227], v244 offset:8704
    v_mfma_f32_16x16x32_bf16 v[28:31], v[228:231], v[180:183], v[28:31]
    s_waitcnt vmcnt(4)
    s_barrier
    s_waitcnt lgkmcnt(4)
    v_mfma_f32_16x16x32_bf16 v[0:3], v[232:235], v[148:151], v[0:3]
    ds_read_b64_tr_b16 v[228:229], v241 offset:8192
    ds_read_b64_tr_b16 v[230:231], v241 offset:8704
    v_mfma_f32_16x16x32_bf16 v[4:7], v[232:235], v[180:183], v[4:7]
    s_waitcnt lgkmcnt(4)
    v_mfma_f32_16x16x32_bf16 v[8:11], v[236:239], v[148:151], v[8:11]
    ds_read_b64_tr_b16 v[232:233], v242 offset:8192
    ds_read_b64_tr_b16 v[234:235], v242 offset:8704
    v_mfma_f32_16x16x32_bf16 v[12:15], v[236:239], v[180:183], v[12:15]
    s_waitcnt lgkmcnt(4)
    v_mfma_f32_16x16x32_bf16 v[16:19], v[224:227], v[152:155], v[16:19]
    ds_read_b64_tr_b16 v[236:237], v243 offset:8192
    ds_read_b64_tr_b16 v[238:239], v243 offset:8704
    v_mfma_f32_16x16x32_bf16 v[20:23], v[224:227], v[184:187], v[20:23]
    s_waitcnt lgkmcnt(4)
    v_mfma_f32_16x16x32_bf16 v[24:27], v[228:231], v[152:155], v[24:27]
    ds_read_b64_tr_b16 v[224:225], v244 offset:12288
    ds_read_b64_tr_b16 v[226:227], v244 offset:12800
    v_mfma_f32_16x16x32_bf16 v[28:31], v[228:231], v[184:187], v[28:31]
    s_waitcnt lgkmcnt(4)
    v_mfma_f32_16x16x32_bf16 v[0:3], v[232:235], v[152:155], v[0:3]
    ds_read_b64_tr_b16 v[228:229], v241 offset:12288
    ds_read_b64_tr_b16 v[230:231], v241 offset:12800
    v_mfma_f32_16x16x32_bf16 v[4:7], v[232:235], v[184:187], v[4:7]
    s_waitcnt lgkmcnt(4)
    v_mfma_f32_16x16x32_bf16 v[8:11], v[236:239], v[152:155], v[8:11]
    ds_read_b64_tr_b16 v[232:233], v242 offset:12288
    ds_read_b64_tr_b16 v[234:235], v242 offset:12800
    v_mfma_f32_16x16x32_bf16 v[12:15], v[236:239], v[184:187], v[12:15]
    s_waitcnt lgkmcnt(4)
    v_mfma_f32_16x16x32_bf16 v[16:19], v[224:227], v[156:159], v[16:19]
    ds_read_b64_tr_b16 v[236:237], v243 offset:12288
    ds_read_b64_tr_b16 v[238:239], v243 offset:12800
    v_mfma_f32_16x16x32_bf16 v[20:23], v[224:227], v[188:191], v[20:23]
    s_waitcnt lgkmcnt(4)
    v_mfma_f32_16x16x32_bf16 v[24:27], v[228:231], v[156:159], v[24:27]
    s_add_u32 s35, s35, 34816
    s_cmp_ge_u32 s35, 139264
    s_cselect_b32 s40, 139264, 0
    s_sub_u32 s35, s35, s40
    v_add_u32 v242, s35, v240
    v_xor_b32 v243, 32, v242
    v_xor_b32 v244, 64, v242
    v_xor_b32 v241, 96, v242
    ds_read_b64_tr_b16 v[224:225], v244 offset:0
    ds_read_b64_tr_b16 v[226:227], v244 offset:512
    v_mfma_f32_16x16x32_bf16 v[28:31], v[228:231], v[188:191], v[28:31]
    s_waitcnt lgkmcnt(4)
    v_mfma_f32_16x16x32_bf16 v[0:3], v[232:235], v[156:159], v[0:3]
    ds_read_b64_tr_b16 v[228:229], v241 offset:0
    ds_read_b64_tr_b16 v[230:231], v241 offset:512
    v_mfma_f32_16x16x32_bf16 v[4:7], v[232:235], v[188:191], v[4:7]
    s_waitcnt lgkmcnt(4)
    v_mfma_f32_16x16x32_bf16 v[8:11], v[236:239], v[156:159], v[8:11]
    ds_read_b64_tr_b16 v[232:233], v242 offset:0
    ds_read_b64_tr_b16 v[234:235], v242 offset:512
    v_mfma_f32_16x16x32_bf16 v[12:15], v[236:239], v[188:191], v[12:15]
    s_waitcnt lgkmcnt(4)
    v_mfma_f32_16x16x32_bf16 v[208:211], v[224:227], v[128:131], 0
    ds_read_b64_tr_b16 v[236:237], v243 offset:0
    ds_read_b64_tr_b16 v[238:239], v243 offset:512
    v_mfma_f32_16x16x32_bf16 v[212:215], v[224:227], v[160:163], 0
    s_waitcnt lgkmcnt(4)
    v_mfma_f32_16x16x32_bf16 v[216:219], v[228:231], v[128:131], 0
    ds_read_b64_tr_b16 v[224:225], v244 offset:4096
    ds_read_b64_tr_b16 v[226:227], v244 offset:4608
    ds_write_b128 v56, v[16:19]
    ds_write_b128 v57, v[20:23]
    ds_write_b128 v58, v[24:27]
    v_mfma_f32_16x16x32_bf16 v[220:223], v[228:231], v[160:163], 0
    ds_write_b128 v59, v[28:31]
    s_waitcnt lgkmcnt(8)
    v_mfma_f32_16x16x32_bf16 v[192:195], v[232:235], v[128:131], 0
    ds_read_b64_tr_b16 v[228:229], v241 offset:4096
    ds_read_b64_tr_b16 v[230:231], v241 offset:4608
    v_mfma_f32_16x16x32_bf16 v[196:199], v[232:235], v[160:163], 0
    s_waitcnt lgkmcnt(8)
    v_mfma_f32_16x16x32_bf16 v[200:203], v[236:239], v[128:131], 0
    ds_read_b64_tr_b16 v[232:233], v242 offset:4096
    ds_read_b64_tr_b16 v[234:235], v242 offset:4608
    v_mfma_f32_16x16x32_bf16 v[204:207], v[236:239], v[160:163], 0
    s_waitcnt lgkmcnt(8)
    v_mfma_f32_16x16x32_bf16 v[208:211], v[224:227], v[132:135], v[208:211]
    ds_read_b64_tr_b16 v[236:237], v243 offset:4096
    ds_read_b64_tr_b16 v[238:239], v243 offset:4608
    v_mfma_f32_16x16x32_bf16 v[212:215], v[224:227], v[164:167], v[212:215]
    s_waitcnt lgkmcnt(4)
    v_mfma_f32_16x16x32_bf16 v[216:219], v[228:231], v[132:135], v[216:219]
    ds_read_b64_tr_b16 v[224:225], v244 offset:8192
    ds_read_b64_tr_b16 v[226:227], v244 offset:8704
    v_mfma_f32_16x16x32_bf16 v[220:223], v[228:231], v[164:167], v[220:223]
    s_waitcnt vmcnt(0)
    s_barrier
    s_waitcnt lgkmcnt(4)
    v_mfma_f32_16x16x32_bf16 v[192:195], v[232:235], v[132:135], v[192:195]
    ds_read_b64_tr_b16 v[228:229], v241 offset:8192
    ds_read_b64_tr_b16 v[230:231], v241 offset:8704
    ds_read_b128 v[32:35], v60
    ds_read_b128 v[36:39], v61
    ds_read_b128 v[40:43], v62
    v_mfma_f32_16x16x32_bf16 v[196:199], v[232:235], v[164:167], v[196:199]
    ds_read_b128 v[44:47], v63
    s_waitcnt lgkmcnt(8)
    v_mfma_f32_16x16x32_bf16 v[200:203], v[236:239], v[132:135], v[200:203]
    ds_read_b64_tr_b16 v[232:233], v242 offset:8192
    ds_read_b64_tr_b16 v[234:235], v242 offset:8704
    v_mfma_f32_16x16x32_bf16 v[204:207], v[236:239], v[164:167], v[204:207]
    s_waitcnt lgkmcnt(2)
    v_add_f32 v32, v32, v0
    v_mfma_f32_16x16x32_bf16 v[208:211], v[224:227], v[136:139], v[208:211]
    ds_read_b64_tr_b16 v[236:237], v243 offset:8192
    ds_read_b64_tr_b16 v[238:239], v243 offset:8704
    v_add_f32 v33, v33, v1
    v_add_f32 v34, v34, v2
    v_add_f32 v35, v35, v3
    v_mfma_f32_16x16x32_bf16 v[212:215], v[224:227], v[168:171], v[212:215]
    v_add_f32 v36, v36, v4
    v_add_f32 v37, v37, v5
    v_add_f32 v38, v38, v6
    v_mfma_f32_16x16x32_bf16 v[216:219], v[228:231], v[136:139], v[216:219]
    ds_read_b64_tr_b16 v[224:225], v244 offset:12288
    ds_read_b64_tr_b16 v[226:227], v244 offset:12800
    v_add_f32 v39, v39, v7
    v_add_f32 v40, v40, v8
    v_add_f32 v41, v41, v9
    v_mfma_f32_16x16x32_bf16 v[220:223], v[228:231], v[168:171], v[220:223]
    v_add_f32 v42, v42, v10
    v_add_f32 v43, v43, v11
    v_add_f32 v44, v44, v12
    s_waitcnt lgkmcnt(4)
    v_mfma_f32_16x16x32_bf16 v[192:195], v[232:235], v[136:139], v[192:195]
    ds_read_b64_tr_b16 v[228:229], v241 offset:12288
    ds_read_b64_tr_b16 v[230:231], v241 offset:12800
    v_add_f32 v45, v45, v13
    v_add_f32 v46, v46, v14
    v_add_f32 v47, v47, v15
    v_mfma_f32_16x16x32_bf16 v[196:199], v[232:235], v[168:171], v[196:199]
    v_cvt_pk_bf16_f32 v48, v32, v33
    v_cvt_pk_bf16_f32 v49, v34, v35
    v_cvt_pk_bf16_f32 v52, v36, v37
    s_waitcnt lgkmcnt(4)
    v_mfma_f32_16x16x32_bf16 v[200:203], v[236:239], v[136:139], v[200:203]
    ds_read_b64_tr_b16 v[232:233], v242 offset:12288
    ds_read_b64_tr_b16 v[234:235], v242 offset:12800
    v_cvt_pk_bf16_f32 v53, v38, v39
    v_cvt_pk_bf16_f32 v50, v40, v41
    v_cvt_pk_bf16_f32 v51, v42, v43
    v_mfma_f32_16x16x32_bf16 v[204:207], v[236:239], v[168:171], v[204:207]
    v_cvt_pk_bf16_f32 v54, v44, v45
    v_cvt_pk_bf16_f32 v55, v46, v47
    buffer_store_dwordx4 v[48:51], v245, s[28:31], s51 offen offset:0 sc1
    buffer_store_dwordx4 v[52:55], v245, s[28:31], s51 offen offset:1024 sc1
    s_add_u32 s51, s51, 2048
    s_nop 0
    s_waitcnt lgkmcnt(4)
    v_mfma_f32_16x16x32_bf16 v[208:211], v[224:227], v[140:143], v[208:211]
    ds_read_b64_tr_b16 v[236:237], v243 offset:12288
    ds_read_b64_tr_b16 v[238:239], v243 offset:12800
    v_mfma_f32_16x16x32_bf16 v[212:215], v[224:227], v[172:175], v[212:215]
    s_waitcnt lgkmcnt(4)
    v_mfma_f32_16x16x32_bf16 v[216:219], v[228:231], v[140:143], v[216:219]
    s_add_u32 s35, s35, 34816
    s_cmp_ge_u32 s35, 139264
    s_cselect_b32 s40, 139264, 0
    s_sub_u32 s35, s35, s40
    v_add_u32 v242, s35, v240
    v_xor_b32 v243, 32, v242
    v_xor_b32 v244, 64, v242
    v_xor_b32 v241, 96, v242
    ds_read_b64_tr_b16 v[224:225], v244 offset:0
    ds_read_b64_tr_b16 v[226:227], v244 offset:512
    v_mfma_f32_16x16x32_bf16 v[220:223], v[228:231], v[172:175], v[220:223]
    s_waitcnt lgkmcnt(4)
    v_mfma_f32_16x16x32_bf16 v[192:195], v[232:235], v[140:143], v[192:195]
    ds_read_b64_tr_b16 v[228:229], v241 offset:0
    ds_read_b64_tr_b16 v[230:231], v241 offset:512
    v_mfma_f32_16x16x32_bf16 v[196:199], v[232:235], v[172:175], v[196:199]
    s_waitcnt lgkmcnt(4)
    v_mfma_f32_16x16x32_bf16 v[200:203], v[236:239], v[140:143], v[200:203]
    ds_read_b64_tr_b16 v[232:233], v242 offset:0
    ds_read_b64_tr_b16 v[234:235], v242 offset:512
    v_mfma_f32_16x16x32_bf16 v[204:207], v[236:239], v[172:175], v[204:207]
    s_waitcnt lgkmcnt(4)
    v_mfma_f32_16x16x32_bf16 v[208:211], v[224:227], v[144:147], v[208:211]
    ds_read_b64_tr_b16 v[236:237], v243 offset:0
    ds_read_b64_tr_b16 v[238:239], v243 offset:512
    v_mfma_f32_16x16x32_bf16 v[212:215], v[224:227], v[176:179], v[212:215]
    s_waitcnt lgkmcnt(4)
    v_mfma_f32_16x16x32_bf16 v[216:219], v[228:231], v[144:147], v[216:219]
    ds_read_b64_tr_b16 v[224:225], v244 offset:4096
    ds_read_b64_tr_b16 v[226:227], v244 offset:4608
    v_mfma_f32_16x16x32_bf16 v[220:223], v[228:231], v[176:179], v[220:223]
    s_waitcnt lgkmcnt(4)
    v_mfma_f32_16x16x32_bf16 v[192:195], v[232:235], v[144:147], v[192:195]
    ds_read_b64_tr_b16 v[228:229], v241 offset:4096
    ds_read_b64_tr_b16 v[230:231], v241 offset:4608
    v_mfma_f32_16x16x32_bf16 v[196:199], v[232:235], v[176:179], v[196:199]
    s_waitcnt lgkmcnt(4)
    v_mfma_f32_16x16x32_bf16 v[200:203], v[236:239], v[144:147], v[200:203]
    ds_read_b64_tr_b16 v[232:233], v242 offset:4096
    ds_read_b64_tr_b16 v[234:235], v242 offset:4608
    v_mfma_f32_16x16x32_bf16 v[204:207], v[236:239], v[176:179], v[204:207]
    s_waitcnt lgkmcnt(4)
    v_mfma_f32_16x16x32_bf16 v[208:211], v[224:227], v[148:151], v[208:211]
    ds_read_b64_tr_b16 v[236:237], v243 offset:4096
    ds_read_b64_tr_b16 v[238:239], v243 offset:4608
    v_mfma_f32_16x16x32_bf16 v[212:215], v[224:227], v[180:183], v[212:215]
    s_waitcnt lgkmcnt(4)
    v_mfma_f32_16x16x32_bf16 v[216:219], v[228:231], v[148:151], v[216:219]
    ds_read_b64_tr_b16 v[224:225], v244 offset:8192
    ds_read_b64_tr_b16 v[226:227], v244 offset:8704
    v_mfma_f32_16x16x32_bf16 v[220:223], v[228:231], v[180:183], v[220:223]
    s_barrier
    s_waitcnt lgkmcnt(4)
    v_mfma_f32_16x16x32_bf16 v[192:195], v[232:235], v[148:151], v[192:195]
    ds_read_b64_tr_b16 v[228:229], v241 offset:8192
    ds_read_b64_tr_b16 v[230:231], v241 offset:8704
    v_mfma_f32_16x16x32_bf16 v[196:199], v[232:235], v[180:183], v[196:199]
    s_waitcnt lgkmcnt(4)
    v_mfma_f32_16x16x32_bf16 v[200:203], v[236:239], v[148:151], v[200:203]
    ds_read_b64_tr_b16 v[232:233], v242 offset:8192
    ds_read_b64_tr_b16 v[234:235], v242 offset:8704
    v_mfma_f32_16x16x32_bf16 v[204:207], v[236:239], v[180:183], v[204:207]
    s_waitcnt lgkmcnt(4)
    v_mfma_f32_16x16x32_bf16 v[208:211], v[224:227], v[152:155], v[208:211]
    ds_read_b64_tr_b16 v[236:237], v243 offset:8192
    ds_read_b64_tr_b16 v[238:239], v243 offset:8704
    v_mfma_f32_16x16x32_bf16 v[212:215], v[224:227], v[184:187], v[212:215]
    s_waitcnt lgkmcnt(4)
    v_mfma_f32_16x16x32_bf16 v[216:219], v[228:231], v[152:155], v[216:219]
    ds_read_b64_tr_b16 v[224:225], v244 offset:12288
    ds_read_b64_tr_b16 v[226:227], v244 offset:12800
    v_mfma_f32_16x16x32_bf16 v[220:223], v[228:231], v[184:187], v[220:223]
    s_waitcnt lgkmcnt(4)
    v_mfma_f32_16x16x32_bf16 v[192:195], v[232:235], v[152:155], v[192:195]
    ds_read_b64_tr_b16 v[228:229], v241 offset:12288
    ds_read_b64_tr_b16 v[230:231], v241 offset:12800
    v_mfma_f32_16x16x32_bf16 v[196:199], v[232:235], v[184:187], v[196:199]
    s_waitcnt lgkmcnt(4)
    v_mfma_f32_16x16x32_bf16 v[200:203], v[236:239], v[152:155], v[200:203]
    ds_read_b64_tr_b16 v[232:233], v242 offset:12288
    ds_read_b64_tr_b16 v[234:235], v242 offset:12800
    v_mfma_f32_16x16x32_bf16 v[204:207], v[236:239], v[184:187], v[204:207]
    s_waitcnt lgkmcnt(4)
    v_mfma_f32_16x16x32_bf16 v[208:211], v[224:227], v[156:159], v[208:211]
    ds_read_b64_tr_b16 v[236:237], v243 offset:12288
    ds_read_b64_tr_b16 v[238:239], v243 offset:12800
    v_mfma_f32_16x16x32_bf16 v[212:215], v[224:227], v[188:191], v[212:215]
    s_waitcnt lgkmcnt(4)
    v_mfma_f32_16x16x32_bf16 v[216:219], v[228:231], v[156:159], v[216:219]
    v_mfma_f32_16x16x32_bf16 v[220:223], v[228:231], v[188:191], v[220:223]
    s_waitcnt lgkmcnt(2)
    v_mfma_f32_16x16x32_bf16 v[192:195], v[232:235], v[156:159], v[192:195]
    v_mfma_f32_16x16x32_bf16 v[196:199], v[232:235], v[188:191], v[196:199]
    s_waitcnt lgkmcnt(0)
    v_mfma_f32_16x16x32_bf16 v[200:203], v[236:239], v[156:159], v[200:203]
    v_mfma_f32_16x16x32_bf16 v[204:207], v[236:239], v[188:191], v[204:207]
    ds_write_b128 v56, v[208:211]
    ds_write_b128 v57, v[212:215]
    ds_write_b128 v58, v[216:219]
    ds_write_b128 v59, v[220:223]
    s_waitcnt lgkmcnt(0)
    s_barrier
    ds_read_b128 v[32:35], v60
    ds_read_b128 v[36:39], v61
    ds_read_b128 v[40:43], v62
    ds_read_b128 v[44:47], v63
    s_waitcnt lgkmcnt(0)
    v_add_f32 v32, v32, v192
    v_add_f32 v33, v33, v193
    v_add_f32 v34, v34, v194
    v_add_f32 v35, v35, v195
    v_add_f32 v36, v36, v196
    v_add_f32 v37, v37, v197
    v_add_f32 v38, v38, v198
    v_add_f32 v39, v39, v199
    v_add_f32 v40, v40, v200
    v_add_f32 v41, v41, v201
    v_add_f32 v42, v42, v202
    v_add_f32 v43, v43, v203
    v_add_f32 v44, v44, v204
    v_add_f32 v45, v45, v205
    v_add_f32 v46, v46, v206
    v_add_f32 v47, v47, v207
    v_cvt_pk_bf16_f32 v48, v32, v33
    v_cvt_pk_bf16_f32 v49, v34, v35
    v_cvt_pk_bf16_f32 v52, v36, v37
    v_cvt_pk_bf16_f32 v53, v38, v39
    v_cvt_pk_bf16_f32 v50, v40, v41
    v_cvt_pk_bf16_f32 v51, v42, v43
    v_cvt_pk_bf16_f32 v54, v44, v45
    v_cvt_pk_bf16_f32 v55, v46, v47
    buffer_store_dwordx4 v[48:51], v245, s[28:31], s51 offen offset:0 sc1
    buffer_store_dwordx4 v[52:55], v245, s[28:31], s51 offen offset:1024 sc1
    s_add_u32 s51, s51, 2048
    s_nop 0
L_attn_exit:
    s_endpgm
L_rare_z:
    s_nop 15
    v_mov_b32 v254, v252
    s_nop 1
    v_permlane16_swap_b32 v252, v254
    v_max_f32 v252, v252, v254
    v_mov_b32 v254, v252
    s_nop 1
    v_permlane32_swap_b32 v252, v254
    v_max_f32 v252, v252, v254
    v_mul_f32 v252, s43, v252
    v_min_f32 v254, v252, v248
    v_sub_f32 v252, v254, v248
    v_exp_f32 v252, v252
    v_mov_b32 v248, v254
    s_nop 0
    v_mul_f32 v250, v250, v252
    v_mov_b32 v254, v253
    s_nop 1
    v_permlane16_swap_b32 v253, v254
    v_max_f32 v253, v253, v254
    v_mov_b32 v254, v253
    s_nop 1
    v_permlane32_swap_b32 v253, v254
    v_max_f32 v253, v253, v254
    v_mul_f32 v253, s43, v253
    v_min_f32 v254, v253, v249
    v_sub_f32 v253, v254, v249
    v_exp_f32 v253, v253
    v_mov_b32 v249, v254
    s_nop 0
    v_mul_f32 v251, v251, v253
    v_mul_f32 v0, v0, v252
    v_mul_f32 v1, v1, v252
    v_mul_f32 v2, v2, v252
    v_mul_f32 v3, v3, v252
    v_mul_f32 v4, v4, v253
    v_mul_f32 v5, v5, v253
    v_mul_f32 v6, v6, v253
    v_mul_f32 v7, v7, v253
    v_mul_f32 v8, v8, v252
    v_mul_f32 v9, v9, v252
    v_mul_f32 v10, v10, v252
    v_mul_f32 v11, v11, v252
    v_mul_f32 v12, v12, v253
    v_mul_f32 v13, v13, v253
    v_mul_f32 v14, v14, v253
    v_mul_f32 v15, v15, v253
    v_mul_f32 v16, v16, v252
    v_mul_f32 v17, v17, v252
    v_mul_f32 v18, v18, v252
    v_mul_f32 v19, v19, v252
    v_mul_f32 v20, v20, v253
    v_mul_f32 v21, v21, v253
    v_mul_f32 v22, v22, v253
    v_mul_f32 v23, v23, v253
    v_mul_f32 v24, v24, v252
    v_mul_f32 v25, v25, v252
    v_mul_f32 v26, v26, v252
    v_mul_f32 v27, v27, v252
    v_mul_f32 v28, v28, v253
    v_mul_f32 v29, v29, v253
    v_mul_f32 v30, v30, v253
    v_mul_f32 v31, v31, v253
    v_mul_f32 v32, v32, v252
    v_mul_f32 v33, v33, v252
    v_mul_f32 v34, v34, v252
    v_mul_f32 v35, v35, v252
    v_mul_f32 v36, v36, v253
    v_mul_f32 v37, v37, v253
    v_mul_f32 v38, v38, v253
    v_mul_f32 v39, v39, v253
    v_mul_f32 v40, v40, v252
    v_mul_f32 v41, v41, v252
    v_mul_f32 v42, v42, v252
    v_mul_f32 v43, v43, v252
    v_mul_f32 v44, v44, v253
    v_mul_f32 v45, v45, v253
    v_mul_f32 v46, v46, v253
    v_mul_f32 v47, v47, v253
    v_mul_f32 v48, v48, v252
    v_mul_f32 v49, v49, v252
    v_mul_f32 v50, v50, v252
    v_mul_f32 v51, v51, v252
    v_mul_f32 v52, v52, v253
    v_mul_f32 v53, v53, v253
    v_mul_f32 v54, v54, v253
    v_mul_f32 v55, v55, v253
    v_mul_f32 v56, v56, v252
    v_mul_f32 v57, v57, v252
    v_mul_f32 v58, v58, v252
    v_mul_f32 v59, v59, v252
    v_mul_f32 v60, v60, v253
    v_mul_f32 v61, v61, v253
    v_mul_f32 v62, v62, v253
    v_mul_f32 v63, v63, v253
    v_mul_f32 v64, v64, v252
    v_mul_f32 v65, v65, v252
    v_mul_f32 v66, v66, v252
    v_mul_f32 v67, v67, v252
    v_mul_f32 v68, v68, v253
    v_mul_f32 v69, v69, v253
    v_mul_f32 v70, v70, v253
    v_mul_f32 v71, v71, v253
    v_mul_f32 v72, v72, v252
    v_mul_f32 v73, v73, v252
    v_mul_f32 v74, v74, v252
    v_mul_f32 v75, v75, v252
    v_mul_f32 v76, v76, v253
    v_mul_f32 v77, v77, v253
    v_mul_f32 v78, v78, v253
    v_mul_f32 v79, v79, v253
    v_mul_f32 v80, v80, v252
    v_mul_f32 v81, v81, v252
    v_mul_f32 v82, v82, v252
    v_mul_f32 v83, v83, v252
    v_mul_f32 v84, v84, v253
    v_mul_f32 v85, v85, v253
    v_mul_f32 v86, v86, v253
    v_mul_f32 v87, v87, v253
    v_mul_f32 v88, v88, v252
    v_mul_f32 v89, v89, v252
    v_mul_f32 v90, v90, v252
    v_mul_f32 v91, v91, v252
    v_mul_f32 v92, v92, v253
    v_mul_f32 v93, v93, v253
    v_mul_f32 v94, v94, v253
    v_mul_f32 v95, v95, v253
    v_mul_f32 v96, v96, v252
    v_mul_f32 v97, v97, v252
    v_mul_f32 v98, v98, v252
    v_mul_f32 v99, v99, v252
    v_mul_f32 v100, v100, v253
    v_mul_f32 v101, v101, v253
    v_mul_f32 v102, v102, v253
    v_mul_f32 v103, v103, v253
    v_mul_f32 v104, v104, v252
    v_mul_f32 v105, v105, v252
    v_mul_f32 v106, v106, v252
    v_mul_f32 v107, v107, v252
    v_mul_f32 v108, v108, v253
    v_mul_f32 v109, v109, v253
    v_mul_f32 v110, v110, v253
    v_mul_f32 v111, v111, v253
    v_mul_f32 v112, v112, v252
    v_mul_f32 v113, v113, v252
    v_mul_f32 v114, v114, v252
    v_mul_f32 v115, v115, v252
    v_mul_f32 v116, v116, v253
    v_mul_f32 v117, v117, v253
    v_mul_f32 v118, v118, v253
    v_mul_f32 v119, v119, v253
    v_mul_f32 v120, v120, v252
    v_mul_f32 v121, v121, v252
    v_mul_f32 v122, v122, v252
    v_mul_f32 v123, v123, v252
    v_mul_f32 v124, v124, v253
    v_mul_f32 v125, v125, v253
    v_mul_f32 v126, v126, v253
    v_mul_f32 v127, v127, v253
    s_nop 1
    s_branch L_back_z
L_rare_y:
    s_nop 15
    v_mov_b32 v254, v252
    s_nop 1
    v_permlane16_swap_b32 v252, v254
    v_max_f32 v252, v252, v254
    v_mov_b32 v254, v252
    s_nop 1
    v_permlane32_swap_b32 v252, v254
    v_max_f32 v252, v252, v254
    v_mul_f32 v252, s43, v252
    v_min_f32 v254, v252, v248
    v_sub_f32 v252, v254, v248
    v_exp_f32 v252, v252
    v_mov_b32 v248, v254
    s_nop 0
    v_mul_f32 v250, v250, v252
    v_mov_b32 v254, v253
    s_nop 1
    v_permlane16_swap_b32 v253, v254
    v_max_f32 v253, v253, v254
    v_mov_b32 v254, v253
    s_nop 1
    v_permlane32_swap_b32 v253, v254
    v_max_f32 v253, v253, v254
    v_mul_f32 v253, s43, v253
    v_min_f32 v254, v253, v249
    v_sub_f32 v253, v254, v249
    v_exp_f32 v253, v253
    v_mov_b32 v249, v254
    s_nop 0
    v_mul_f32 v251, v251, v253
    v_mul_f32 v0, v0, v252
    v_mul_f32 v1, v1, v252
    v_mul_f32 v2, v2, v252
    v_mul_f32 v3, v3, v252
    v_mul_f32 v4, v4, v253
    v_mul_f32 v5, v5, v253
    v_mul_f32 v6, v6, v253
    v_mul_f32 v7, v7, v253
    v_mul_f32 v8, v8, v252
    v_mul_f32 v9, v9, v252
    v_mul_f32 v10, v10, v252
    v_mul_f32 v11, v11, v252
    v_mul_f32 v12, v12, v253
    v_mul_f32 v13, v13, v253
    v_mul_f32 v14, v14, v253
    v_mul_f32 v15, v15, v253
    v_mul_f32 v16, v16, v252
    v_mul_f32 v17, v17, v252
    v_mul_f32 v18, v18, v252
    v_mul_f32 v19, v19, v252
    v_mul_f32 v20, v20, v253
    v_mul_f32 v21, v21, v253
    v_mul_f32 v22, v22, v253
    v_mul_f32 v23, v23, v253
    v_mul_f32 v24, v24, v252
    v_mul_f32 v25, v25, v252
    v_mul_f32 v26, v26, v252
    v_mul_f32 v27, v27, v252
    v_mul_f32 v28, v28, v253
    v_mul_f32 v29, v29, v253
    v_mul_f32 v30, v30, v253
    v_mul_f32 v31, v31, v253
    v_mul_f32 v32, v32, v252
    v_mul_f32 v33, v33, v252
    v_mul_f32 v34, v34, v252
    v_mul_f32 v35, v35, v252
    v_mul_f32 v36, v36, v253
    v_mul_f32 v37, v37, v253
    v_mul_f32 v38, v38, v253
    v_mul_f32 v39, v39, v253
    v_mul_f32 v40, v40, v252
    v_mul_f32 v41, v41, v252
    v_mul_f32 v42, v42, v252
    v_mul_f32 v43, v43, v252
    v_mul_f32 v44, v44, v253
    v_mul_f32 v45, v45, v253
    v_mul_f32 v46, v46, v253
    v_mul_f32 v47, v47, v253
    v_mul_f32 v48, v48, v252
    v_mul_f32 v49, v49, v252
    v_mul_f32 v50, v50, v252
    v_mul_f32 v51, v51, v252
    v_mul_f32 v52, v52, v253
    v_mul_f32 v53, v53, v253
    v_mul_f32 v54, v54, v253
    v_mul_f32 v55, v55, v253
    v_mul_f32 v56, v56, v252
    v_mul_f32 v57, v57, v252
    v_mul_f32 v58, v58, v252
    v_mul_f32 v59, v59, v252
    v_mul_f32 v60, v60, v253
    v_mul_f32 v61, v61, v253
    v_mul_f32 v62, v62, v253
    v_mul_f32 v63, v63, v253
    v_mul_f32 v64, v64, v252
    v_mul_f32 v65, v65, v252
    v_mul_f32 v66, v66, v252
    v_mul_f32 v67, v67, v252
    v_mul_f32 v68, v68, v253
    v_mul_f32 v69, v69, v253
    v_mul_f32 v70, v70, v253
    v_mul_f32 v71, v71, v253
    v_mul_f32 v72, v72, v252
    v_mul_f32 v73, v73, v252
    v_mul_f32 v74, v74, v252
    v_mul_f32 v75, v75, v252
    v_mul_f32 v76, v76, v253
    v_mul_f32 v77, v77, v253
    v_mul_f32 v78, v78, v253
    v_mul_f32 v79, v79, v253
    v_mul_f32 v80, v80, v252
    v_mul_f32 v81, v81, v252
    v_mul_f32 v82, v82, v252
    v_mul_f32 v83, v83, v252
    v_mul_f32 v84, v84, v253
    v_mul_f32 v85, v85, v253
    v_mul_f32 v86, v86, v253
    v_mul_f32 v87, v87, v253
    v_mul_f32 v88, v88, v252
    v_mul_f32 v89, v89, v252
    v_mul_f32 v90, v90, v252
    v_mul_f32 v91, v91, v252
    v_mul_f32 v92, v92, v253
    v_mul_f32 v93, v93, v253
    v_mul_f32 v94, v94, v253
    v_mul_f32 v95, v95, v253
    v_mul_f32 v96, v96, v252
    v_mul_f32 v97, v97, v252
    v_mul_f32 v98, v98, v252
    v_mul_f32 v99, v99, v252
    v_mul_f32 v100, v100, v253
    v_mul_f32 v101, v101, v253
    v_mul_f32 v102, v102, v253
    v_mul_f32 v103, v103, v253
    v_mul_f32 v104, v104, v252
    v_mul_f32 v105, v105, v252
    v_mul_f32 v106, v106, v252
    v_mul_f32 v107, v107, v252
    v_mul_f32 v108, v108, v253
    v_mul_f32 v109, v109, v253
    v_mul_f32 v110, v110, v253
    v_mul_f32 v111, v111, v253
    v_mul_f32 v112, v112, v252
    v_mul_f32 v113, v113, v252
    v_mul_f32 v114, v114, v252
    v_mul_f32 v115, v115, v252
    v_mul_f32 v116, v116, v253
    v_mul_f32 v117, v117, v253
    v_mul_f32 v118, v118, v253
    v_mul_f32 v119, v119, v253
    v_mul_f32 v120, v120, v252
    v_mul_f32 v121, v121, v252
    v_mul_f32 v122, v122, v252
    v_mul_f32 v123, v123, v252
    v_mul_f32 v124, v124, v253
    v_mul_f32 v125, v125, v253
    v_mul_f32 v126, v126, v253
    v_mul_f32 v127, v127, v253
    s_nop 1
    s_branch L_back_y
L_rare_a:
    s_nop 15
    v_mov_b32 v254, v252
    s_nop 1
    v_permlane16_swap_b32 v252, v254
    v_max_f32 v252, v252, v254
    v_mov_b32 v254, v252
    s_nop 1
    v_permlane32_swap_b32 v252, v254
    v_max_f32 v252, v252, v254
    v_mul_f32 v252, s43, v252
    v_min_f32 v254, v252, v248
    v_sub_f32 v252, v254, v248
    v_exp_f32 v252, v252
    v_mov_b32 v248, v254
    s_nop 0
    v_mul_f32 v250, v250, v252
    v_mov_b32 v254, v253
    s_nop 1
    v_permlane16_swap_b32 v253, v254
    v_max_f32 v253, v253, v254
    v_mov_b32 v254, v253
    s_nop 1
    v_permlane32_swap_b32 v253, v254
    v_max_f32 v253, v253, v254
    v_mul_f32 v253, s43, v253
    v_min_f32 v254, v253, v249
    v_sub_f32 v253, v254, v249
    v_exp_f32 v253, v253
    v_mov_b32 v249, v254
    s_nop 0
    v_mul_f32 v251, v251, v253
    v_mul_f32 v0, v0, v252
    v_mul_f32 v1, v1, v252
    v_mul_f32 v2, v2, v252
    v_mul_f32 v3, v3, v252
    v_mul_f32 v4, v4, v253
    v_mul_f32 v5, v5, v253
    v_mul_f32 v6, v6, v253
    v_mul_f32 v7, v7, v253
    v_mul_f32 v8, v8, v252
    v_mul_f32 v9, v9, v252
    v_mul_f32 v10, v10, v252
    v_mul_f32 v11, v11, v252
    v_mul_f32 v12, v12, v253
    v_mul_f32 v13, v13, v253
    v_mul_f32 v14, v14, v253
    v_mul_f32 v15, v15, v253
    v_mul_f32 v16, v16, v252
    v_mul_f32 v17, v17, v252
    v_mul_f32 v18, v18, v252
    v_mul_f32 v19, v19, v252
    v_mul_f32 v20, v20, v253
    v_mul_f32 v21, v21, v253
    v_mul_f32 v22, v22, v253
    v_mul_f32 v23, v23, v253
    v_mul_f32 v24, v24, v252
    v_mul_f32 v25, v25, v252
    v_mul_f32 v26, v26, v252
    v_mul_f32 v27, v27, v252
    v_mul_f32 v28, v28, v253
    v_mul_f32 v29, v29, v253
    v_mul_f32 v30, v30, v253
    v_mul_f32 v31, v31, v253
    v_mul_f32 v32, v32, v252
    v_mul_f32 v33, v33, v252
    v_mul_f32 v34, v34, v252
    v_mul_f32 v35, v35, v252
    v_mul_f32 v36, v36, v253
    v_mul_f32 v37, v37, v253
    v_mul_f32 v38, v38, v253
    v_mul_f32 v39, v39, v253
    v_mul_f32 v40, v40, v252
    v_mul_f32 v41, v41, v252
    v_mul_f32 v42, v42, v252
    v_mul_f32 v43, v43, v252
    v_mul_f32 v44, v44, v253
    v_mul_f32 v45, v45, v253
    v_mul_f32 v46, v46, v253
    v_mul_f32 v47, v47, v253
    v_mul_f32 v48, v48, v252
    v_mul_f32 v49, v49, v252
    v_mul_f32 v50, v50, v252
    v_mul_f32 v51, v51, v252
    v_mul_f32 v52, v52, v253
    v_mul_f32 v53, v53, v253
    v_mul_f32 v54, v54, v253
    v_mul_f32 v55, v55, v253
    v_mul_f32 v56, v56, v252
    v_mul_f32 v57, v57, v252
    v_mul_f32 v58, v58, v252
    v_mul_f32 v59, v59, v252
    v_mul_f32 v60, v60, v253
    v_mul_f32 v61, v61, v253
    v_mul_f32 v62, v62, v253
    v_mul_f32 v63, v63, v253
    v_mul_f32 v64, v64, v252
    v_mul_f32 v65, v65, v252
    v_mul_f32 v66, v66, v252
    v_mul_f32 v67, v67, v252
    v_mul_f32 v68, v68, v253
    v_mul_f32 v69, v69, v253
    v_mul_f32 v70, v70, v253
    v_mul_f32 v71, v71, v253
    v_mul_f32 v72, v72, v252
    v_mul_f32 v73, v73, v252
    v_mul_f32 v74, v74, v252
    v_mul_f32 v75, v75, v252
    v_mul_f32 v76, v76, v253
    v_mul_f32 v77, v77, v253
    v_mul_f32 v78, v78, v253
    v_mul_f32 v79, v79, v253
    v_mul_f32 v80, v80, v252
    v_mul_f32 v81, v81, v252
    v_mul_f32 v82, v82, v252
    v_mul_f32 v83, v83, v252
    v_mul_f32 v84, v84, v253
    v_mul_f32 v85, v85, v253
    v_mul_f32 v86, v86, v253
    v_mul_f32 v87, v87, v253
    v_mul_f32 v88, v88, v252
    v_mul_f32 v89, v89, v252
    v_mul_f32 v90, v90, v252
    v_mul_f32 v91, v91, v252
    v_mul_f32 v92, v92, v253
    v_mul_f32 v93, v93, v253
    v_mul_f32 v94, v94, v253
    v_mul_f32 v95, v95, v253
    v_mul_f32 v96, v96, v252
    v_mul_f32 v97, v97, v252
    v_mul_f32 v98, v98, v252
    v_mul_f32 v99, v99, v252
    v_mul_f32 v100, v100, v253
    v_mul_f32 v101, v101, v253
    v_mul_f32 v102, v102, v253
    v_mul_f32 v103, v103, v253
    v_mul_f32 v104, v104, v252
    v_mul_f32 v105, v105, v252
    v_mul_f32 v106, v106, v252
    v_mul_f32 v107, v107, v252
    v_mul_f32 v108, v108, v253
    v_mul_f32 v109, v109, v253
    v_mul_f32 v110, v110, v253
    v_mul_f32 v111, v111, v253
    v_mul_f32 v112, v112, v252
    v_mul_f32 v113, v113, v252
    v_mul_f32 v114, v114, v252
    v_mul_f32 v115, v115, v252
    v_mul_f32 v116, v116, v253
    v_mul_f32 v117, v117, v253
    v_mul_f32 v118, v118, v253
    v_mul_f32 v119, v119, v253
    v_mul_f32 v120, v120, v252
    v_mul_f32 v121, v121, v252
    v_mul_f32 v122, v122, v252
    v_mul_f32 v123, v123, v252
    v_mul_f32 v124, v124, v253
    v_mul_f32 v125, v125, v253
    v_mul_f32 v126, v126, v253
    v_mul_f32 v127, v127, v253
    s_nop 1
    s_branch L_back_a
L_rare_b:
    s_nop 15
    v_mov_b32 v254, v252
    s_nop 1
    v_permlane16_swap_b32 v252, v254
    v_max_f32 v252, v252, v254
    v_mov_b32 v254, v252
    s_nop 1
    v_permlane32_swap_b32 v252, v254
    v_max_f32 v252, v252, v254
    v_mul_f32 v252, s43, v252
    v_min_f32 v254, v252, v248
    v_sub_f32 v252, v254, v248
    v_exp_f32 v252, v252
    v_mov_b32 v248, v254
    s_nop 0
    v_mul_f32 v250, v250, v252
    v_mov_b32 v254, v253
    s_nop 1
    v_permlane16_swap_b32 v253, v254
    v_max_f32 v253, v253, v254
    v_mov_b32 v254, v253
    s_nop 1
    v_permlane32_swap_b32 v253, v254
    v_max_f32 v253, v253, v254
    v_mul_f32 v253, s43, v253
    v_min_f32 v254, v253, v249
    v_sub_f32 v253, v254, v249
    v_exp_f32 v253, v253
    v_mov_b32 v249, v254
    s_nop 0
    v_mul_f32 v251, v251, v253
    v_mul_f32 v0, v0, v252
    v_mul_f32 v1, v1, v252
    v_mul_f32 v2, v2, v252
    v_mul_f32 v3, v3, v252
    v_mul_f32 v4, v4, v253
    v_mul_f32 v5, v5, v253
    v_mul_f32 v6, v6, v253
    v_mul_f32 v7, v7, v253
    v_mul_f32 v8, v8, v252
    v_mul_f32 v9, v9, v252
    v_mul_f32 v10, v10, v252
    v_mul_f32 v11, v11, v252
    v_mul_f32 v12, v12, v253
    v_mul_f32 v13, v13, v253
    v_mul_f32 v14, v14, v253
    v_mul_f32 v15, v15, v253
    v_mul_f32 v16, v16, v252
    v_mul_f32 v17, v17, v252
    v_mul_f32 v18, v18, v252
    v_mul_f32 v19, v19, v252
    v_mul_f32 v20, v20, v253
    v_mul_f32 v21, v21, v253
    v_mul_f32 v22, v22, v253
    v_mul_f32 v23, v23, v253
    v_mul_f32 v24, v24, v252
    v_mul_f32 v25, v25, v252
    v_mul_f32 v26, v26, v252
    v_mul_f32 v27, v27, v252
    v_mul_f32 v28, v28, v253
    v_mul_f32 v29, v29, v253
    v_mul_f32 v30, v30, v253
    v_mul_f32 v31, v31, v253
    v_mul_f32 v32, v32, v252
    v_mul_f32 v33, v33, v252
    v_mul_f32 v34, v34, v252
    v_mul_f32 v35, v35, v252
    v_mul_f32 v36, v36, v253
    v_mul_f32 v37, v37, v253
    v_mul_f32 v38, v38, v253
    v_mul_f32 v39, v39, v253
    v_mul_f32 v40, v40, v252
    v_mul_f32 v41, v41, v252
    v_mul_f32 v42, v42, v252
    v_mul_f32 v43, v43, v252
    v_mul_f32 v44, v44, v253
    v_mul_f32 v45, v45, v253
    v_mul_f32 v46, v46, v253
    v_mul_f32 v47, v47, v253
    v_mul_f32 v48, v48, v252
    v_mul_f32 v49, v49, v252
    v_mul_f32 v50, v50, v252
    v_mul_f32 v51, v51, v252
    v_mul_f32 v52, v52, v253
    v_mul_f32 v53, v53, v253
    v_mul_f32 v54, v54, v253
    v_mul_f32 v55, v55, v253
    v_mul_f32 v56, v56, v252
    v_mul_f32 v57, v57, v252
    v_mul_f32 v58, v58, v252
    v_mul_f32 v59, v59, v252
    v_mul_f32 v60, v60, v253
    v_mul_f32 v61, v61, v253
    v_mul_f32 v62, v62, v253
    v_mul_f32 v63, v63, v253
    v_mul_f32 v64, v64, v252
    v_mul_f32 v65, v65, v252
    v_mul_f32 v66, v66, v252
    v_mul_f32 v67, v67, v252
    v_mul_f32 v68, v68, v253
    v_mul_f32 v69, v69, v253
    v_mul_f32 v70, v70, v253
    v_mul_f32 v71, v71, v253
    v_mul_f32 v72, v72, v252
    v_mul_f32 v73, v73, v252
    v_mul_f32 v74, v74, v252
    v_mul_f32 v75, v75, v252
    v_mul_f32 v76, v76, v253
    v_mul_f32 v77, v77, v253
    v_mul_f32 v78, v78, v253
    v_mul_f32 v79, v79, v253
    v_mul_f32 v80, v80, v252
    v_mul_f32 v81, v81, v252
    v_mul_f32 v82, v82, v252
    v_mul_f32 v83, v83, v252
    v_mul_f32 v84, v84, v253
    v_mul_f32 v85, v85, v253
    v_mul_f32 v86, v86, v253
    v_mul_f32 v87, v87, v253
    v_mul_f32 v88, v88, v252
    v_mul_f32 v89, v89, v252
    v_mul_f32 v90, v90, v252
    v_mul_f32 v91, v91, v252
    v_mul_f32 v92, v92, v253
    v_mul_f32 v93, v93, v253
    v_mul_f32 v94, v94, v253
    v_mul_f32 v95, v95, v253
    v_mul_f32 v96, v96, v252
    v_mul_f32 v97, v97, v252
    v_mul_f32 v98, v98, v252
    v_mul_f32 v99, v99, v252
    v_mul_f32 v100, v100, v253
    v_mul_f32 v101, v101, v253
    v_mul_f32 v102, v102, v253
    v_mul_f32 v103, v103, v253
    v_mul_f32 v104, v104, v252
    v_mul_f32 v105, v105, v252
    v_mul_f32 v106, v106, v252
    v_mul_f32 v107, v107, v252
    v_mul_f32 v108, v108, v253
    v_mul_f32 v109, v109, v253
    v_mul_f32 v110, v110, v253
    v_mul_f32 v111, v111, v253
    v_mul_f32 v112, v112, v252
    v_mul_f32 v113, v113, v252
    v_mul_f32 v114, v114, v252
    v_mul_f32 v115, v115, v252
    v_mul_f32 v116, v116, v253
    v_mul_f32 v117, v117, v253
    v_mul_f32 v118, v118, v253
    v_mul_f32 v119, v119, v253
    v_mul_f32 v120, v120, v252
    v_mul_f32 v121, v121, v252
    v_mul_f32 v122, v122, v252
    v_mul_f32 v123, v123, v252
    v_mul_f32 v124, v124, v253
    v_mul_f32 v125, v125, v253
    v_mul_f32 v126, v126, v253
    v_mul_f32 v127, v127, v253
    s_nop 1
    s_branch L_back_b
L_rare_c:
    s_nop 15
    v_mov_b32 v254, v252
    s_nop 1
    v_permlane16_swap_b32 v252, v254
    v_max_f32 v252, v252, v254
    v_mov_b32 v254, v252
    s_nop 1
    v_permlane32_swap_b32 v252, v254
    v_max_f32 v252, v252, v254
    v_mul_f32 v252, s43, v252
    v_min_f32 v254, v252, v248
    v_sub_f32 v252, v254, v248
    v_exp_f32 v252, v252
    v_mov_b32 v248, v254
    s_nop 0
    v_mul_f32 v250, v250, v252
    v_mov_b32 v254, v253
    s_nop 1
    v_permlane16_swap_b32 v253, v254
    v_max_f32 v253, v253, v254
    v_mov_b32 v254, v253
    s_nop 1
    v_permlane32_swap_b32 v253, v254
    v_max_f32 v253, v253, v254
    v_mul_f32 v253, s43, v253
    v_min_f32 v254, v253, v249
    v_sub_f32 v253, v254, v249
    v_exp_f32 v253, v253
    v_mov_b32 v249, v254
    s_nop 0
    v_mul_f32 v251, v251, v253
    v_mul_f32 v0, v0, v252
    v_mul_f32 v1, v1, v252
    v_mul_f32 v2, v2, v252
    v_mul_f32 v3, v3, v252
    v_mul_f32 v4, v4, v253
    v_mul_f32 v5, v5, v253
    v_mul_f32 v6, v6, v253
    v_mul_f32 v7, v7, v253
    v_mul_f32 v8, v8, v252
    v_mul_f32 v9, v9, v252
    v_mul_f32 v10, v10, v252
    v_mul_f32 v11, v11, v252
    v_mul_f32 v12, v12, v253
    v_mul_f32 v13, v13, v253
    v_mul_f32 v14, v14, v253
    v_mul_f32 v15, v15, v253
    v_mul_f32 v16, v16, v252
    v_mul_f32 v17, v17, v252
    v_mul_f32 v18, v18, v252
    v_mul_f32 v19, v19, v252
    v_mul_f32 v20, v20, v253
    v_mul_f32 v21, v21, v253
    v_mul_f32 v22, v22, v253
    v_mul_f32 v23, v23, v253
    v_mul_f32 v24, v24, v252
    v_mul_f32 v25, v25, v252
    v_mul_f32 v26, v26, v252
    v_mul_f32 v27, v27, v252
    v_mul_f32 v28, v28, v253
    v_mul_f32 v29, v29, v253
    v_mul_f32 v30, v30, v253
    v_mul_f32 v31, v31, v253
    v_mul_f32 v32, v32, v252
    v_mul_f32 v33, v33, v252
    v_mul_f32 v34, v34, v252
    v_mul_f32 v35, v35, v252
    v_mul_f32 v36, v36, v253
    v_mul_f32 v37, v37, v253
    v_mul_f32 v38, v38, v253
    v_mul_f32 v39, v39, v253
    v_mul_f32 v40, v40, v252
    v_mul_f32 v41, v41, v252
    v_mul_f32 v42, v42, v252
    v_mul_f32 v43, v43, v252
    v_mul_f32 v44, v44, v253
    v_mul_f32 v45, v45, v253
    v_mul_f32 v46, v46, v253
    v_mul_f32 v47, v47, v253
    v_mul_f32 v48, v48, v252
    v_mul_f32 v49, v49, v252
    v_mul_f32 v50, v50, v252
    v_mul_f32 v51, v51, v252
    v_mul_f32 v52, v52, v253
    v_mul_f32 v53, v53, v253
    v_mul_f32 v54, v54, v253
    v_mul_f32 v55, v55, v253
    v_mul_f32 v56, v56, v252
    v_mul_f32 v57, v57, v252
    v_mul_f32 v58, v58, v252
    v_mul_f32 v59, v59, v252
    v_mul_f32 v60, v60, v253
    v_mul_f32 v61, v61, v253
    v_mul_f32 v62, v62, v253
    v_mul_f32 v63, v63, v253
    v_mul_f32 v64, v64, v252
    v_mul_f32 v65, v65, v252
    v_mul_f32 v66, v66, v252
    v_mul_f32 v67, v67, v252
    v_mul_f32 v68, v68, v253
    v_mul_f32 v69, v69, v253
    v_mul_f32 v70, v70, v253
    v_mul_f32 v71, v71, v253
    v_mul_f32 v72, v72, v252
    v_mul_f32 v73, v73, v252
    v_mul_f32 v74, v74, v252
    v_mul_f32 v75, v75, v252
    v_mul_f32 v76, v76, v253
    v_mul_f32 v77, v77, v253
    v_mul_f32 v78, v78, v253
    v_mul_f32 v79, v79, v253
    v_mul_f32 v80, v80, v252
    v_mul_f32 v81, v81, v252
    v_mul_f32 v82, v82, v252
    v_mul_f32 v83, v83, v252
    v_mul_f32 v84, v84, v253
    v_mul_f32 v85, v85, v253
    v_mul_f32 v86, v86, v253
    v_mul_f32 v87, v87, v253
    v_mul_f32 v88, v88, v252
    v_mul_f32 v89, v89, v252
    v_mul_f32 v90, v90, v252
    v_mul_f32 v91, v91, v252
    v_mul_f32 v92, v92, v253
    v_mul_f32 v93, v93, v253
    v_mul_f32 v94, v94, v253
    v_mul_f32 v95, v95, v253
    v_mul_f32 v96, v96, v252
    v_mul_f32 v97, v97, v252
    v_mul_f32 v98, v98, v252
    v_mul_f32 v99, v99, v252
    v_mul_f32 v100, v100, v253
    v_mul_f32 v101, v101, v253
    v_mul_f32 v102, v102, v253
    v_mul_f32 v103, v103, v253
    v_mul_f32 v104, v104, v252
    v_mul_f32 v105, v105, v252
    v_mul_f32 v106, v106, v252
    v_mul_f32 v107, v107, v252
    v_mul_f32 v108, v108, v253
    v_mul_f32 v109, v109, v253
    v_mul_f32 v110, v110, v253
    v_mul_f32 v111, v111, v253
    v_mul_f32 v112, v112, v252
    v_mul_f32 v113, v113, v252
    v_mul_f32 v114, v114, v252
    v_mul_f32 v115, v115, v252
    v_mul_f32 v116, v116, v253
    v_mul_f32 v117, v117, v253
    v_mul_f32 v118, v118, v253
    v_mul_f32 v119, v119, v253
    v_mul_f32 v120, v120, v252
    v_mul_f32 v121, v121, v252
    v_mul_f32 v122, v122, v252
    v_mul_f32 v123, v123, v252
    v_mul_f32 v124, v124, v253
    v_mul_f32 v125, v125, v253
    v_mul_f32 v126, v126, v253
    v_mul_f32 v127, v127, v253
    s_nop 1
    s_branch L_back_c
L_rare_d:
    s_nop 15
    v_mov_b32 v254, v252
    s_nop 1
    v_permlane16_swap_b32 v252, v254
    v_max_f32 v252, v252, v254
    v_mov_b32 v254, v252
    s_nop 1
    v_permlane32_swap_b32 v252, v254
    v_max_f32 v252, v252, v254
    v_mul_f32 v252, s43, v252
    v_min_f32 v254, v252, v248
    v_sub_f32 v252, v254, v248
    v_exp_f32 v252, v252
    v_mov_b32 v248, v254
    s_nop 0
    v_mul_f32 v250, v250, v252
    v_mov_b32 v254, v253
    s_nop 1
    v_permlane16_swap_b32 v253, v254
    v_max_f32 v253, v253, v254
    v_mov_b32 v254, v253
    s_nop 1
    v_permlane32_swap_b32 v253, v254
    v_max_f32 v253, v253, v254
    v_mul_f32 v253, s43, v253
    v_min_f32 v254, v253, v249
    v_sub_f32 v253, v254, v249
    v_exp_f32 v253, v253
    v_mov_b32 v249, v254
    s_nop 0
    v_mul_f32 v251, v251, v253
    v_mul_f32 v0, v0, v252
    v_mul_f32 v1, v1, v252
    v_mul_f32 v2, v2, v252
    v_mul_f32 v3, v3, v252
    v_mul_f32 v4, v4, v253
    v_mul_f32 v5, v5, v253
    v_mul_f32 v6, v6, v253
    v_mul_f32 v7, v7, v253
    v_mul_f32 v8, v8, v252
    v_mul_f32 v9, v9, v252
    v_mul_f32 v10, v10, v252
    v_mul_f32 v11, v11, v252
    v_mul_f32 v12, v12, v253
    v_mul_f32 v13, v13, v253
    v_mul_f32 v14, v14, v253
    v_mul_f32 v15, v15, v253
    v_mul_f32 v16, v16, v252
    v_mul_f32 v17, v17, v252
    v_mul_f32 v18, v18, v252
    v_mul_f32 v19, v19, v252
    v_mul_f32 v20, v20, v253
    v_mul_f32 v21, v21, v253
    v_mul_f32 v22, v22, v253
    v_mul_f32 v23, v23, v253
    v_mul_f32 v24, v24, v252
    v_mul_f32 v25, v25, v252
    v_mul_f32 v26, v26, v252
    v_mul_f32 v27, v27, v252
    v_mul_f32 v28, v28, v253
    v_mul_f32 v29, v29, v253
    v_mul_f32 v30, v30, v253
    v_mul_f32 v31, v31, v253
    v_mul_f32 v32, v32, v252
    v_mul_f32 v33, v33, v252
    v_mul_f32 v34, v34, v252
    v_mul_f32 v35, v35, v252
    v_mul_f32 v36, v36, v253
    v_mul_f32 v37, v37, v253
    v_mul_f32 v38, v38, v253
    v_mul_f32 v39, v39, v253
    v_mul_f32 v40, v40, v252
    v_mul_f32 v41, v41, v252
    v_mul_f32 v42, v42, v252
    v_mul_f32 v43, v43, v252
    v_mul_f32 v44, v44, v253
    v_mul_f32 v45, v45, v253
    v_mul_f32 v46, v46, v253
    v_mul_f32 v47, v47, v253
    v_mul_f32 v48, v48, v252
    v_mul_f32 v49, v49, v252
    v_mul_f32 v50, v50, v252
    v_mul_f32 v51, v51, v252
    v_mul_f32 v52, v52, v253
    v_mul_f32 v53, v53, v253
    v_mul_f32 v54, v54, v253
    v_mul_f32 v55, v55, v253
    v_mul_f32 v56, v56, v252
    v_mul_f32 v57, v57, v252
    v_mul_f32 v58, v58, v252
    v_mul_f32 v59, v59, v252
    v_mul_f32 v60, v60, v253
    v_mul_f32 v61, v61, v253
    v_mul_f32 v62, v62, v253
    v_mul_f32 v63, v63, v253
    v_mul_f32 v64, v64, v252
    v_mul_f32 v65, v65, v252
    v_mul_f32 v66, v66, v252
    v_mul_f32 v67, v67, v252
    v_mul_f32 v68, v68, v253
    v_mul_f32 v69, v69, v253
    v_mul_f32 v70, v70, v253
    v_mul_f32 v71, v71, v253
    v_mul_f32 v72, v72, v252
    v_mul_f32 v73, v73, v252
    v_mul_f32 v74, v74, v252
    v_mul_f32 v75, v75, v252
    v_mul_f32 v76, v76, v253
    v_mul_f32 v77, v77, v253
    v_mul_f32 v78, v78, v253
    v_mul_f32 v79, v79, v253
    v_mul_f32 v80, v80, v252
    v_mul_f32 v81, v81, v252
    v_mul_f32 v82, v82, v252
    v_mul_f32 v83, v83, v252
    v_mul_f32 v84, v84, v253
    v_mul_f32 v85, v85, v253
    v_mul_f32 v86, v86, v253
    v_mul_f32 v87, v87, v253
    v_mul_f32 v88, v88, v252
    v_mul_f32 v89, v89, v252
    v_mul_f32 v90, v90, v252
    v_mul_f32 v91, v91, v252
    v_mul_f32 v92, v92, v253
    v_mul_f32 v93, v93, v253
    v_mul_f32 v94, v94, v253
    v_mul_f32 v95, v95, v253
    v_mul_f32 v96, v96, v252
    v_mul_f32 v97, v97, v252
    v_mul_f32 v98, v98, v252
    v_mul_f32 v99, v99, v252
    v_mul_f32 v100, v100, v253
    v_mul_f32 v101, v101, v253
    v_mul_f32 v102, v102, v253
    v_mul_f32 v103, v103, v253
    v_mul_f32 v104, v104, v252
    v_mul_f32 v105, v105, v252
    v_mul_f32 v106, v106, v252
    v_mul_f32 v107, v107, v252
    v_mul_f32 v108, v108, v253
    v_mul_f32 v109, v109, v253
    v_mul_f32 v110, v110, v253
    v_mul_f32 v111, v111, v253
    v_mul_f32 v112, v112, v252
    v_mul_f32 v113, v113, v252
    v_mul_f32 v114, v114, v252
    v_mul_f32 v115, v115, v252
    v_mul_f32 v116, v116, v253
    v_mul_f32 v117, v117, v253
    v_mul_f32 v118, v118, v253
    v_mul_f32 v119, v119, v253
    v_mul_f32 v120, v120, v252
    v_mul_f32 v121, v121, v252
    v_mul_f32 v122, v122, v252
    v_mul_f32 v123, v123, v252
    v_mul_f32 v124, v124, v253
    v_mul_f32 v125, v125, v253
    v_mul_f32 v126, v126, v253
    v_mul_f32 v127, v127, v253
    s_nop 1
    s_branch L_back_d
L_rare_e:
    s_nop 15
    v_mov_b32 v254, v252
    s_nop 1
    v_permlane16_swap_b32 v252, v254
    v_max_f32 v252, v252, v254
    v_mov_b32 v254, v252
    s_nop 1
    v_permlane32_swap_b32 v252, v254
    v_max_f32 v252, v252, v254
    v_mul_f32 v252, s43, v252
    v_min_f32 v254, v252, v248
    v_sub_f32 v252, v254, v248
    v_exp_f32 v252, v252
    v_mov_b32 v248, v254
    s_nop 0
    v_mul_f32 v250, v250, v252
    v_mov_b32 v254, v253
    s_nop 1
    v_permlane16_swap_b32 v253, v254
    v_max_f32 v253, v253, v254
    v_mov_b32 v254, v253
    s_nop 1
    v_permlane32_swap_b32 v253, v254
    v_max_f32 v253, v253, v254
    v_mul_f32 v253, s43, v253
    v_min_f32 v254, v253, v249
    v_sub_f32 v253, v254, v249
    v_exp_f32 v253, v253
    v_mov_b32 v249, v254
    s_nop 0
    v_mul_f32 v251, v251, v253
    v_mul_f32 v0, v0, v252
    v_mul_f32 v1, v1, v252
    v_mul_f32 v2, v2, v252
    v_mul_f32 v3, v3, v252
    v_mul_f32 v4, v4, v253
    v_mul_f32 v5, v5, v253
    v_mul_f32 v6, v6, v253
    v_mul_f32 v7, v7, v253
    v_mul_f32 v8, v8, v252
    v_mul_f32 v9, v9, v252
    v_mul_f32 v10, v10, v252
    v_mul_f32 v11, v11, v252
    v_mul_f32 v12, v12, v253
    v_mul_f32 v13, v13, v253
    v_mul_f32 v14, v14, v253
    v_mul_f32 v15, v15, v253
    v_mul_f32 v16, v16, v252
    v_mul_f32 v17, v17, v252
    v_mul_f32 v18, v18, v252
    v_mul_f32 v19, v19, v252
    v_mul_f32 v20, v20, v253
    v_mul_f32 v21, v21, v253
    v_mul_f32 v22, v22, v253
    v_mul_f32 v23, v23, v253
    v_mul_f32 v24, v24, v252
    v_mul_f32 v25, v25, v252
    v_mul_f32 v26, v26, v252
    v_mul_f32 v27, v27, v252
    v_mul_f32 v28, v28, v253
    v_mul_f32 v29, v29, v253
    v_mul_f32 v30, v30, v253
    v_mul_f32 v31, v31, v253
    v_mul_f32 v32, v32, v252
    v_mul_f32 v33, v33, v252
    v_mul_f32 v34, v34, v252
    v_mul_f32 v35, v35, v252
    v_mul_f32 v36, v36, v253
    v_mul_f32 v37, v37, v253
    v_mul_f32 v38, v38, v253
    v_mul_f32 v39, v39, v253
    v_mul_f32 v40, v40, v252
    v_mul_f32 v41, v41, v252
    v_mul_f32 v42, v42, v252
    v_mul_f32 v43, v43, v252
    v_mul_f32 v44, v44, v253
    v_mul_f32 v45, v45, v253
    v_mul_f32 v46, v46, v253
    v_mul_f32 v47, v47, v253
    v_mul_f32 v48, v48, v252
    v_mul_f32 v49, v49, v252
    v_mul_f32 v50, v50, v252
    v_mul_f32 v51, v51, v252
    v_mul_f32 v52, v52, v253
    v_mul_f32 v53, v53, v253
    v_mul_f32 v54, v54, v253
    v_mul_f32 v55, v55, v253
    v_mul_f32 v56, v56, v252
    v_mul_f32 v57, v57, v252
    v_mul_f32 v58, v58, v252
    v_mul_f32 v59, v59, v252
    v_mul_f32 v60, v60, v253
    v_mul_f32 v61, v61, v253
    v_mul_f32 v62, v62, v253
    v_mul_f32 v63, v63, v253
    v_mul_f32 v64, v64, v252
    v_mul_f32 v65, v65, v252
    v_mul_f32 v66, v66, v252
    v_mul_f32 v67, v67, v252
    v_mul_f32 v68, v68, v253
    v_mul_f32 v69, v69, v253
    v_mul_f32 v70, v70, v253
    v_mul_f32 v71, v71, v253
    v_mul_f32 v72, v72, v252
    v_mul_f32 v73, v73, v252
    v_mul_f32 v74, v74, v252
    v_mul_f32 v75, v75, v252
    v_mul_f32 v76, v76, v253
    v_mul_f32 v77, v77, v253
    v_mul_f32 v78, v78, v253
    v_mul_f32 v79, v79, v253
    v_mul_f32 v80, v80, v252
    v_mul_f32 v81, v81, v252
    v_mul_f32 v82, v82, v252
    v_mul_f32 v83, v83, v252
    v_mul_f32 v84, v84, v253
    v_mul_f32 v85, v85, v253
    v_mul_f32 v86, v86, v253
    v_mul_f32 v87, v87, v253
    v_mul_f32 v88, v88, v252
    v_mul_f32 v89, v89, v252
    v_mul_f32 v90, v90, v252
    v_mul_f32 v91, v91, v252
    v_mul_f32 v92, v92, v253
    v_mul_f32 v93, v93, v253
    v_mul_f32 v94, v94, v253
    v_mul_f32 v95, v95, v253
    v_mul_f32 v96, v96, v252
    v_mul_f32 v97, v97, v252
    v_mul_f32 v98, v98, v252
    v_mul_f32 v99, v99, v252
    v_mul_f32 v100, v100, v253
    v_mul_f32 v101, v101, v253
    v_mul_f32 v102, v102, v253
    v_mul_f32 v103, v103, v253
    v_mul_f32 v104, v104, v252
    v_mul_f32 v105, v105, v252
    v_mul_f32 v106, v106, v252
    v_mul_f32 v107, v107, v252
    v_mul_f32 v108, v108, v253
    v_mul_f32 v109, v109, v253
    v_mul_f32 v110, v110, v253
    v_mul_f32 v111, v111, v253
    v_mul_f32 v112, v112, v252
    v_mul_f32 v113, v113, v252
    v_mul_f32 v114, v114, v252
    v_mul_f32 v115, v115, v252
    v_mul_f32 v116, v116, v253
    v_mul_f32 v117, v117, v253
    v_mul_f32 v118, v118, v253
    v_mul_f32 v119, v119, v253
    v_mul_f32 v120, v120, v252
    v_mul_f32 v121, v121, v252
    v_mul_f32 v122, v122, v252
    v_mul_f32 v123, v123, v252
    v_mul_f32 v124, v124, v253
    v_mul_f32 v125, v125, v253
    v_mul_f32 v126, v126, v253
    v_mul_f32 v127, v127, v253
    s_nop 1
    s_branch L_back_e
.globl reduce_kernel
.p2align 8
.type reduce_kernel,@function
reduce_kernel:
    s_cmp_ge_u32 s2, 896
    s_cbranch_scc1 L_red_exit
    s_load_dwordx2 s[4:5], s[0:1], 80
    s_load_dwordx2 s[6:7], s[0:1], 96
    s_mul_hi_u32 s8, s2, 0x924924a
    s_mul_i32 s9, s8, 28
    s_sub_u32 s9, s2, s9
    v_lshlrev_b32 v4, 4, v0
    s_lshl_b32 s26, s9, 12
    s_lshl_b32 s9, s9, 1
    v_lshrrev_b32 v3, 7, v0
    v_add_u32 v3, s9, v3
    s_waitcnt lgkmcnt(0)
    s_mul_i32 s10, s8, 917504
    s_add_u32 s6, s6, s10
    s_addc_u32 s7, s7, 0
    s_mov_b32 s12, s6
    s_and_b32 s13, s7, 0xffff
    s_mov_b32 s14, 917504
    s_mov_b32 s15, 0x00020000
    s_mov_b32 s16, s4
    s_and_b32 s17, s5, 0xffff
    s_mov_b32 s18, 3670016
    s_mov_b32 s19, 0x00020000
    s_add_u32 s20, s26, 0
    buffer_load_dwordx4 v[24:27], v4, s[12:15], s20 offen
    s_add_u32 s20, s26, 114688
    buffer_load_dwordx4 v[28:31], v4, s[12:15], s20 offen
    s_add_u32 s20, s26, 229376
    buffer_load_dwordx4 v[32:35], v4, s[12:15], s20 offen
    s_add_u32 s20, s26, 344064
    buffer_load_dwordx4 v[36:39], v4, s[12:15], s20 offen
    s_add_u32 s20, s26, 458752
    buffer_load_dwordx4 v[40:43], v4, s[12:15], s20 offen
    s_add_u32 s20, s26, 573440
    buffer_load_dwordx4 v[44:47], v4, s[12:15], s20 offen
    s_add_u32 s20, s26, 688128
    buffer_load_dwordx4 v[48:51], v4, s[12:15], s20 offen
    s_add_u32 s20, s26, 802816
    buffer_load_dwordx4 v[52:55], v4, s[12:15], s20 offen
    s_and_b32 s21, s8, 15
    s_lshr_b32 s22, s8, 4
    s_mul_i32 s21, s21, 229376
    s_mul_i32 s22, s22, 896
    s_add_u32 s21, s21, s22
    s_mov_b32 s23, 0xffff0000
    v_mul_u32_u24 v5, 37, v3
    v_lshrrev_b32 v5, 8, v5
    v_mul_u32_u24 v6, 7, v5
    v_sub_u32 v6, v3, v6
    v_and_b32 v8, 15, v0
    v_bfe_u32 v9, v0, 6, 1
    v_lshl_add_u32 v8, v9, 4, v8
    v_and_b32 v9, 3, v5
    v_lshl_add_u32 v8, v9, 5, v8
    v_mul_u32_u24 v8, 1792, v8
    v_bfe_u32 v9, v0, 4, 2
    v_lshl_add_u32 v8, v9, 3, v8
    v_lshrrev_b32 v9, 2, v5
    v_lshl_add_u32 v8, v9, 6, v8
    v_lshl_add_u32 v8, v6, 7, v8
    s_waitcnt vmcnt(7)
    v_lshlrev_b32 v16, 16, v24
    v_and_b32 v17, s23, v24
    v_lshlrev_b32 v18, 16, v25
    v_and_b32 v19, s23, v25
    v_lshlrev_b32 v20, 16, v26
    v_and_b32 v21, s23, v26
    v_lshlrev_b32 v22, 16, v27
    v_and_b32 v23, s23, v27
    s_waitcnt vmcnt(6)
    v_lshlrev_b32 v11, 16, v28
    v_and_b32 v12, s23, v28
    v_add_f32 v16, v16, v11
    v_add_f32 v17, v17, v12
    v_lshlrev_b32 v11, 16, v29
    v_and_b32 v12, s23, v29
    v_add_f32 v18, v18, v11
    v_add_f32 v19, v19, v12
    v_lshlrev_b32 v11, 16, v30
    v_and_b32 v12, s23, v30
    v_add_f32 v20, v20, v11
    v_add_f32 v21, v21, v12
    v_lshlrev_b32 v11, 16, v31
    v_and_b32 v12, s23, v31
    v_add_f32 v22, v22, v11
    v_add_f32 v23, v23, v12
    s_waitcnt vmcnt(5)
    v_lshlrev_b32 v11, 16, v32
    v_and_b32 v12, s23, v32
    v_add_f32 v16, v16, v11
    v_add_f32 v17, v17, v12
    v_lshlrev_b32 v11, 16, v33
    v_and_b32 v12, s23, v33
    v_add_f32 v18, v18, v11
    v_add_f32 v19, v19, v12
    v_lshlrev_b32 v11, 16, v34
    v_and_b32 v12, s23, v34
    v_add_f32 v20, v20, v11
    v_add_f32 v21, v21, v12
    v_lshlrev_b32 v11, 16, v35
    v_and_b32 v12, s23, v35
    v_add_f32 v22, v22, v11
    v_add_f32 v23, v23, v12
    s_waitcnt vmcnt(4)
    v_lshlrev_b32 v11, 16, v36
    v_and_b32 v12, s23, v36
    v_add_f32 v16, v16, v11
    v_add_f32 v17, v17, v12
    v_lshlrev_b32 v11, 16, v37
    v_and_b32 v12, s23, v37
    v_add_f32 v18, v18, v11
    v_add_f32 v19, v19, v12
    v_lshlrev_b32 v11, 16, v38
    v_and_b32 v12, s23, v38
    v_add_f32 v20, v20, v11
    v_add_f32 v21, v21, v12
    v_lshlrev_b32 v11, 16, v39
    v_and_b32 v12, s23, v39
    v_add_f32 v22, v22, v11
    v_add_f32 v23, v23, v12
    s_waitcnt vmcnt(3)
    v_lshlrev_b32 v11, 16, v40
    v_and_b32 v12, s23, v40
    v_add_f32 v16, v16, v11
    v_add_f32 v17, v17, v12
    v_lshlrev_b32 v11, 16, v41
    v_and_b32 v12, s23, v41
    v_add_f32 v18, v18, v11
    v_add_f32 v19, v19, v12
    v_lshlrev_b32 v11, 16, v42
    v_and_b32 v12, s23, v42
    v_add_f32 v20, v20, v11
    v_add_f32 v21, v21, v12
    v_lshlrev_b32 v11, 16, v43
    v_and_b32 v12, s23, v43
    v_add_f32 v22, v22, v11
    v_add_f32 v23, v23, v12
    s_waitcnt vmcnt(2)
    v_lshlrev_b32 v11, 16, v44
    v_and_b32 v12, s23, v44
    v_add_f32 v16, v16, v11
    v_add_f32 v17, v17, v12
    v_lshlrev_b32 v11, 16, v45
    v_and_b32 v12, s23, v45
    v_add_f32 v18, v18, v11
    v_add_f32 v19, v19, v12
    v_lshlrev_b32 v11, 16, v46
    v_and_b32 v12, s23, v46
    v_add_f32 v20, v20, v11
    v_add_f32 v21, v21, v12
    v_lshlrev_b32 v11, 16, v47
    v_and_b32 v12, s23, v47
    v_add_f32 v22, v22, v11
    v_add_f32 v23, v23, v12
    s_waitcnt vmcnt(1)
    v_lshlrev_b32 v11, 16, v48
    v_and_b32 v12, s23, v48
    v_add_f32 v16, v16, v11
    v_add_f32 v17, v17, v12
    v_lshlrev_b32 v11, 16, v49
    v_and_b32 v12, s23, v49
    v_add_f32 v18, v18, v11
    v_add_f32 v19, v19, v12
    v_lshlrev_b32 v11, 16, v50
    v_and_b32 v12, s23, v50
    v_add_f32 v20, v20, v11
    v_add_f32 v21, v21, v12
    v_lshlrev_b32 v11, 16, v51
    v_and_b32 v12, s23, v51
    v_add_f32 v22, v22, v11
    v_add_f32 v23, v23, v12
    s_waitcnt vmcnt(0)
    v_lshlrev_b32 v11, 16, v52
    v_and_b32 v12, s23, v52
    v_add_f32 v16, v16, v11
    v_add_f32 v17, v17, v12
    v_lshlrev_b32 v11, 16, v53
    v_and_b32 v12, s23, v53
    v_add_f32 v18, v18, v11
    v_add_f32 v19, v19, v12
    v_lshlrev_b32 v11, 16, v54
    v_and_b32 v12, s23, v54
    v_add_f32 v20, v20, v11
    v_add_f32 v21, v21, v12
    v_lshlrev_b32 v11, 16, v55
    v_and_b32 v12, s23, v55
    v_add_f32 v22, v22, v11
    v_add_f32 v23, v23, v12
    v_cvt_pk_bf16_f32 v12, v16, v17
    v_cvt_pk_bf16_f32 v13, v18, v19
    v_cvt_pk_bf16_f32 v14, v20, v21
    v_cvt_pk_bf16_f32 v15, v22, v23
    buffer_store_dwordx2 v[12:13], v8, s[16:19], s21 offen
    buffer_store_dwordx2 v[14:15], v8, s[16:19], s21 offen offset:32
L_red_exit:
    s_endpgm
.section .rodata,"a"
.p2align 6
.amdhsa_kernel attn_kernel
  .amdhsa_next_free_vgpr 256
  .amdhsa_next_free_sgpr 102
  .amdhsa_accum_offset 256
  .amdhsa_group_segment_fixed_size 0
  .amdhsa_kernarg_size 104
  .amdhsa_user_sgpr_count 2
  .amdhsa_user_sgpr_kernarg_segment_ptr 1
  .amdhsa_system_sgpr_workgroup_id_x 1
.end_amdhsa_kernel
.p2align 6
.amdhsa_kernel reduce_kernel
  .amdhsa_next_free_vgpr 56
  .amdhsa_next_free_sgpr 32
  .amdhsa_accum_offset 56
  .amdhsa_group_segment_fixed_size 0
  .amdhsa_kernarg_size 104
  .amdhsa_user_sgpr_count 2
  .amdhsa_user_sgpr_kernarg_segment_ptr 1
  .amdhsa_system_sgpr_workgroup_id_x 1
.end_amdhsa_kernel
```
